```python
import torch

def _softmax(x, axis=-1):
    return torch.softmax(x, dim=axis)
def _gelu(x):
    return torch.nn.functional.gelu(x, approximate="tanh")
def _silu(x):
    return torch.nn.functional.silu(x)
def _sigmoid(x):
    return torch.sigmoid(x)
def _layernorm(x, axis=-1, eps=1e-5):
    m = x.mean(dim=axis, keepdim=True)
    v = x.var(dim=axis, keepdim=True, unbiased=False)
    return (x - m) / torch.sqrt(v + eps)
def _scatter_add(tgt, idx, src, axis=0):
    return tgt.clone().index_add_(axis, idx, src)
def _segment_sum(src, seg, n):
    out = torch.zeros((n,) + src.shape[1:], dtype=src.dtype)
    return out.index_add_(0, seg, src)
def _pad(x, pw):
    flat = tuple(v for pair in reversed(pw) for v in pair)
    return torch.nn.functional.pad(x, flat)

kernel_name = 'standalone__gqa_block_cached__decode'

def setup_inputs():

    _w = (lambda a: (lambda t: t.to(torch.bfloat16) if t.is_floating_point() else t)(torch.as_tensor(a)))
    B, Sq, D = 8, 1, 640
    Hq, Hkv, Sk, Dh = 32, 32, 4096, 192
    assert Hq % Hkv == 0, (Hq, Hkv)
    return {
        "x": _w((lambda *s: torch.randn(*s, dtype=torch.bfloat16) * 0.8)(B, Sq, D)),
        "k_cache": _w((lambda *s: torch.randn(*s, dtype=torch.bfloat16) * 0.8)(B, Hkv, Sk, Dh)),
        "v_cache": _w((lambda *s: torch.randn(*s, dtype=torch.bfloat16) * 0.05)(B, Hkv, Sk, Dh)),
        "wq": _w((lambda *s: torch.randn(*s, dtype=torch.bfloat16) * 0.8)(D, Hq * Dh) * (D ** -0.5)),
        "wo": _w((lambda *s: torch.randn(*s, dtype=torch.bfloat16) * 0.05)(Hq * Dh, D) * ((Hq * Dh) ** -0.5)),
    }

def reference(x, k_cache, v_cache, wq, wo):
    B, Sq, D = x.shape
    Hq, Dh = 32, 192
    Hkv = k_cache.shape[1]
    rep = Hq // Hkv
    q = (lambda x, *d: x.permute(*d))((x @ wq).reshape(B, Sq, Hq, Dh), 0, 2, 1, 3)
    k = (lambda x, n, axis: torch.repeat_interleave(x, n, dim=axis))(k_cache, rep, axis=1)
    v = (lambda x, n, axis: torch.repeat_interleave(x, n, dim=axis))(v_cache, rep, axis=1)
    scores = torch.einsum("bhqd,bhkd->bhqk", q, k) * (Dh ** -0.5)
    p = _softmax(scores, axis=-1)
    o = torch.einsum("bhqk,bhkd->bhqd", p, v)
    return (lambda x, *d: x.permute(*d))(o, 0, 2, 1, 3).reshape(B, Sq, Hq * Dh) @ wo
```

```asm
; @launch grid=(256,1,1) block=(256,1,1) lds=62304
.amdgcn_target "amdgcn-amd-amdhsa--gfx950"
.text
.globl standalone__gqa_block_cached__decode_kernel
.p2align 8
.type standalone__gqa_block_cached__decode_kernel,@function
standalone__gqa_block_cached__decode_kernel:
  s_cmp_ge_u32 s2, 256
  s_cbranch_scc1 L_end
  s_load_dwordx16 s[40:55], s[0:1], 0
  v_lshrrev_b32 v1, 6, v0
  s_nop 0
  v_readfirstlane_b32 s56, v1
  v_and_b32 v0, 63, v0
  s_and_b32 s58, s2, 7
  s_lshl_b32 s58, s58, 2
  s_bfe_u32 s69, s2, 131075
  s_add_u32 s58, s58, s69
  s_lshr_b32 s57, s2, 5
  s_lshl_b32 s59, s57, 5
  s_add_u32 s59, s59, s58
  v_and_b32 v1, 7, v0
  v_lshlrev_b32 v1, 4, v1
  v_lshrrev_b32 v2, 3, v0
  v_and_b32 v3, 1, v2
  v_lshrrev_b32 v4, 4, v0
  v_mul_u32_u24 v48, 40, v2
  v_mul_u32_u24 v54, 245760, v2
  v_add_u32 v54, v54, v1
  v_add_u32 v6, 1, v2
  v_mul_u32_u24 v6, 11, v6
  v_lshrrev_b32 v6, 5, v6
  v_mul_u32_u24 v6, 84, v6
  v_mul_u32_u24 v7, 85, v2
  v_add_u32 v7, 84, v7
  v_sub_u32 v7, v7, v6
  v_mul_u32_u24 v7, 384, v7
  v_add_u32 v7, v7, v1
  v_lshlrev_b32 v8, 7, v3
  v_lshlrev_b32 v9, 8, v3
  v_sub_u32 v9, 256, v9
  v_add_u32 v12, v7, v8
  v_add_u32 v13, v7, v9
  s_mul_i32 s63, s56, 393216
  s_add_u32 s64, s63, 196608
  s_mul_i32 s69, s57, 1280
  s_mul_i32 s70, s56, 320
  s_add_u32 s69, s69, s70
  s_mul_i32 s60, s58, 384
  s_mul_i32 s70, s56, 1966080
  s_add_u32 s70, s60, s70
  s_mul_i32 s60, s59, 1572864
  s_mov_b32 s26, 320
  s_mov_b32 s27, 0x20000
  s_mov_b32 s18, 1954176
  s_mov_b32 s19, 0x20000
  s_mov_b32 s10, 1572864
  s_mov_b32 s11, 0x20000
  s_mov_b32 s14, 1572864
  s_mov_b32 s15, 0x20000
  s_waitcnt lgkmcnt(0)
  s_add_u32 s24, s40, s69
  s_addc_u32 s25, s41, 0
  s_add_u32 s16, s46, s70
  s_addc_u32 s17, s47, 0
  s_add_u32 s8, s42, s60
  s_addc_u32 s9, s43, 0
  s_add_u32 s12, s44, s60
  s_addc_u32 s13, s45, 0
  v_min_u32 v255, 59, v0
  v_mul_u32_u24 v254, 43, v255
  v_lshrrev_b32 v254, 7, v254
  v_mul_u32_u24 v253, 11904, v254
  v_lshl_add_u32 v255, v255, 7, v253
  s_mul_i32 s74, s57, 245760
  buffer_load_dword v253, v255, s[16:19], s74 offen
  buffer_load_dwordx4 v[20:23], v48, s[24:27], 0 offen
  buffer_load_dwordx4 v[24:27], v48, s[24:27], 0 offen offset:16
  buffer_load_dwordx2 v[28:29], v48, s[24:27], 0 offen offset:32
  s_mov_b32 s71, 0
  buffer_load_dwordx4 a[216:219], v54, s[16:19], s71 offen nt
  buffer_load_dwordx4 v[112:115], v12, s[8:11], s63 offen nt
  buffer_load_dwordx4 a[220:223], v54, s[16:19], s71 offen offset:128 nt
  buffer_load_dwordx4 v[116:119], v12, s[8:11], s63 offen offset:128 nt
  buffer_load_dwordx4 a[224:227], v54, s[16:19], s71 offen offset:256 nt
  buffer_load_dwordx4 v[120:123], v13, s[8:11], s63 offen nt
  buffer_load_dwordx4 v[124:127], v12, s[8:11], s64 offen nt
  s_mul_i32 s69, s57, 81920
  s_add_u32 s69, s69, 1048576
  s_add_u32 s28, s54, s69
  s_addc_u32 s29, s55, 0
  s_mov_b32 s30, 81920
  s_mov_b32 s31, 0x20000
  v_mov_b32 v232, -1
  v_mov_b32 v233, -1
  v_mov_b32 v234, -1
  v_mov_b32 v235, -1
  s_mul_i32 s95, s56, 20480
  s_mul_i32 s69, s58, 640
  s_add_u32 s95, s95, s69
  v_lshlrev_b32 v6, 4, v0
  s_mov_b32 exec_hi, 0xff
  buffer_store_dwordx4 v[232:235], v6, s[28:31], s95 offen sc1
  s_mov_b32 exec_hi, -1
  v_mov_b32 v5, 0
  s_lshr_b32 s101, s2, 3
  s_add_u32 s96, s54, 262144
  s_addc_u32 s97, s55, 0
  s_mov_b32 s98, 532480
  s_mov_b32 s99, 0x20000
  s_mul_i32 s70, s101, 16640
  s_lshl_b32 s69, s2, 2
  s_add_u32 s69, s69, s56
  v_xor_b32 v6, s69, v0
  v_and_b32 v6, 31, v6
  v_cmp_eq_u32 vcc, 0, v6
  v_mul_u32_u24 v6, 256, v0
  s_mov_b64 exec, vcc
  buffer_store_dword v5, v6, s[96:99], s70 offen sc1
  s_mov_b64 exec, -1
  v_mul_u32_u24 v6, 384, v4
  v_mul_u32_u24 v7, 32640, v3
  v_add_u32 v6, v6, v7
  v_add_u32 v6, v6, v1
  v_add_u32 v10, v6, v8
  v_add_u32 v11, v6, v9
  s_bfe_u32 s69, s2, 196611
  s_mul_i32 s69, s69, 63
  s_bfe_u32 s70, s2, 131078
  s_mul_i32 s70, s70, 3
  s_add_u32 s69, s69, s70
  s_add_u32 s69, s69, s56
  v_lshlrev_b32 v6, 3, v0
  v_add_u32 v6, s69, v6
  v_subrev_u32 v7, 504, v6
  v_cmp_le_u32 vcc, 504, v6
  s_nop 1
  v_cndmask_b32 v6, v6, v7, vcc
  v_mul_u32_u24 v7, 1561, v6
  v_lshrrev_b32 v7, 15, v7
  v_mul_u32_u24 v57, 43, v7
  v_lshrrev_b32 v57, 7, v57
  v_mul_u32_u24 v7, 87, v7
  v_sub_u32 v7, v7, v57
  v_lshl_add_u32 v7, v6, 2, v7
  v_and_b32 v14, 0xffff, v7
  v_lshlrev_b32 v6, 3, v0
  v_add_u32 v6, 4, v6
  v_add_u32 v6, s69, v6
  v_subrev_u32 v7, 504, v6
  v_cmp_le_u32 vcc, 504, v6
  s_nop 1
  v_cndmask_b32 v6, v6, v7, vcc
  v_mul_u32_u24 v7, 1561, v6
  v_lshrrev_b32 v7, 15, v7
  v_mul_u32_u24 v57, 43, v7
  v_lshrrev_b32 v57, 7, v57
  v_mul_u32_u24 v7, 87, v7
  v_sub_u32 v7, v7, v57
  v_lshl_add_u32 v7, v6, 2, v7
  v_lshl_or_b32 v14, v7, 16, v14
  s_mul_i32 s69, s58, 245760
  s_mul_i32 s70, s56, 61440
  s_add_u32 s69, s69, s70
  s_add_u32 s20, s48, s69
  s_addc_u32 s21, s49, 0
  s_mov_b32 s22, 61440
  s_mov_b32 s23, 0x20000
  s_mul_i32 s69, s57, 1280
  s_add_u32 s32, s50, s69
  s_addc_u32 s33, s51, 0
  s_mov_b32 s34, 1280
  s_mov_b32 s35, 0x20000
  s_mov_b32 s36, s52
  s_mov_b32 s37, s53
  s_mov_b32 s38, 256
  s_mov_b32 s39, 0x20000
  s_mov_b32 s65, 0x3fb8aa3b
  s_mov_b32 s66, 0x3d93cd3a
  s_mov_b32 s67, 0x01000100
  s_mov_b32 s68, 0x03020302
  s_mov_b32 s72, 0xffff0000
  v_mul_u32_u24 v55, 15360, v4
  v_add_u32 v55, v55, v8
  v_add_u32 v55, v55, v1
  v_and_b32 v6, 1, v0
  v_lshlrev_b32 v6, 4, v6
  v_mov_b32 v7, 0xffff
  v_lshlrev_b32 v7, v6, v7
  v_bfe_u32 v6, v0, 1, 2
  v_cmp_eq_u32 vcc, 0, v6
  s_nop 1
  v_cndmask_b32 v16, 0, v7, vcc
  v_cmp_eq_u32 vcc, 1, v6
  s_nop 1
  v_cndmask_b32 v17, 0, v7, vcc
  v_cmp_eq_u32 vcc, 2, v6
  s_nop 1
  v_cndmask_b32 v18, 0, v7, vcc
  v_cmp_eq_u32 vcc, 3, v6
  s_nop 1
  v_cndmask_b32 v19, 0, v7, vcc
  v_mov_b32 v5, 0
  ds_write_b32 v5, v5 offset:13856
  s_getreg_b32 s79, hwreg(HW_REG_XCC_ID)
  s_and_b32 s79, s79, 1
  s_mul_i32 s79, s79, 90
  s_add_u32 s79, s79, 115
  v_mov_b32 v58, s79
  v_mov_b32 v59, s79
  ds_write_b64 v5, v[58:59] offset:13896
  ds_write_b32 v5, v5 offset:13904
  s_and_b32 s100, s2, 7
  v_mov_b32 v32, 0
  v_mov_b32 v33, 0
  v_mov_b32 v34, 0
  v_mov_b32 v35, 0
  v_mov_b32 v36, 0
  v_mov_b32 v37, 0
  v_mov_b32 v38, 0
  v_mov_b32 v39, 0
  v_mov_b32 v40, 0
  v_mov_b32 v41, 0
  v_mov_b32 v42, 0
  v_mov_b32 v43, 0
  s_waitcnt vmcnt(8)
  s_mov_b32 s71, 12288
  buffer_load_dwordx4 a[228:231], v54, s[16:19], s71 offen nt
  s_waitcnt vmcnt(8)
  buffer_load_dwordx4 v[128:131], v12, s[8:11], s64 offen offset:128 nt
  s_waitcnt vmcnt(8)
  buffer_load_dwordx4 a[232:235], v54, s[16:19], s71 offen offset:128 nt
  v_perm_b32 v51, v20, v20, s67
  v_and_b32 v44, v51, v16
  v_and_b32 v45, v51, v17
  v_and_b32 v46, v51, v18
  v_and_b32 v47, v51, v19
  s_nop 1
  v_mfma_f32_16x16x32_bf16 v[32:35], v[44:47], a[216:219], v[32:35]
  v_min_u32 v255, 59, v0
  v_lshlrev_b32 v255, 7, v255
  s_mul_i32 s74, s57, 7680
  buffer_load_dword v253, v255, s[20:23], s74 offen
  s_waitcnt vmcnt(8)
  v_readlane_b32 s61, v14, 0
  buffer_load_dwordx4 v[132:135], v13, s[8:11], s64 offen nt
  v_mfma_f32_16x16x32_bf16 v[36:39], v[44:47], a[220:223], v[36:39]
  s_waitcnt vmcnt(8)
  s_and_b32 s60, s61, 0xffff
  s_mul_i32 s60, s60, 384
  buffer_load_dwordx4 v[136:139], v10, s[8:11], s60 offen nt
  s_waitcnt vmcnt(8)
  buffer_load_dwordx4 a[236:239], v54, s[16:19], s71 offen offset:256 nt
  v_mfma_f32_16x16x32_bf16 v[40:43], v[44:47], a[224:227], v[40:43]
  s_waitcnt vmcnt(8)
  buffer_load_dwordx4 v[140:143], v10, s[8:11], s60 offen offset:128 nt
  s_waitcnt vmcnt(8)
  s_mov_b32 s71, 24576
  buffer_load_dwordx4 a[240:243], v54, s[16:19], s71 offen nt
  s_waitcnt vmcnt(8)
  buffer_load_dwordx4 v[144:147], v11, s[8:11], s60 offen nt
  v_perm_b32 v51, v20, v20, s68
  v_and_b32 v44, v51, v16
  v_and_b32 v45, v51, v17
  v_and_b32 v46, v51, v18
  v_and_b32 v47, v51, v19
  s_nop 1
  v_mfma_f32_16x16x32_bf16 v[32:35], v[44:47], a[228:231], v[32:35]
  s_waitcnt vmcnt(8)
  buffer_load_dwordx4 a[244:247], v54, s[16:19], s71 offen offset:128 nt
  s_waitcnt vmcnt(8)
  s_lshr_b32 s60, s61, 16
  s_mul_i32 s60, s60, 384
  buffer_load_dwordx4 v[148:151], v10, s[8:11], s60 offen nt
  v_mfma_f32_16x16x32_bf16 v[36:39], v[44:47], a[232:235], v[36:39]
  s_waitcnt vmcnt(8)
  v_readlane_b32 s61, v14, 1
  buffer_load_dwordx4 v[152:155], v10, s[8:11], s60 offen offset:128 nt
  s_waitcnt vmcnt(8)
  buffer_load_dwordx4 a[248:251], v54, s[16:19], s71 offen offset:256 nt
  s_waitcnt vmcnt(8)
  buffer_load_dwordx4 v[156:159], v11, s[8:11], s60 offen nt
  s_waitcnt vmcnt(8)
  s_mov_b32 s71, 36864
  buffer_load_dwordx4 a[252:255], v54, s[16:19], s71 offen nt
  v_mfma_f32_16x16x32_bf16 v[40:43], v[44:47], a[236:239], v[40:43]
  s_waitcnt vmcnt(8)
  s_and_b32 s60, s61, 0xffff
  s_mul_i32 s60, s60, 384
  buffer_load_dwordx4 v[160:163], v10, s[8:11], s60 offen nt
  s_waitcnt vmcnt(8)
  buffer_load_dwordx4 v[164:167], v10, s[8:11], s60 offen offset:128 nt
  v_perm_b32 v51, v21, v21, s67
  v_and_b32 v44, v51, v16
  v_and_b32 v45, v51, v17
  v_and_b32 v46, v51, v18
  v_and_b32 v47, v51, v19
  s_nop 1
  v_mfma_f32_16x16x32_bf16 v[32:35], v[44:47], a[240:243], v[32:35]
  s_waitcnt vmcnt(8)
  buffer_load_dwordx4 a[216:219], v54, s[16:19], s71 offen offset:128 nt
  s_waitcnt vmcnt(8)
  buffer_load_dwordx4 v[168:171], v11, s[8:11], s60 offen nt
  v_mfma_f32_16x16x32_bf16 v[36:39], v[44:47], a[244:247], v[36:39]
  s_waitcnt vmcnt(8)
  buffer_load_dwordx4 a[220:223], v54, s[16:19], s71 offen offset:256 nt
  s_waitcnt vmcnt(8)
  s_lshr_b32 s60, s61, 16
  s_mul_i32 s60, s60, 384
  buffer_load_dwordx4 v[172:175], v10, s[8:11], s60 offen nt
  s_waitcnt vmcnt(8)
  s_mov_b32 s71, 49152
  buffer_load_dwordx4 a[224:227], v54, s[16:19], s71 offen nt
  v_mfma_f32_16x16x32_bf16 v[40:43], v[44:47], a[248:251], v[40:43]
  s_waitcnt vmcnt(8)
  v_readlane_b32 s61, v14, 2
  buffer_load_dwordx4 v[176:179], v10, s[8:11], s60 offen offset:128 nt
  s_waitcnt vmcnt(8)
  buffer_load_dwordx4 v[180:183], v11, s[8:11], s60 offen nt
  v_perm_b32 v51, v21, v21, s68
  v_and_b32 v44, v51, v16
  v_and_b32 v45, v51, v17
  v_and_b32 v46, v51, v18
  v_and_b32 v47, v51, v19
  s_nop 1
  v_mfma_f32_16x16x32_bf16 v[32:35], v[44:47], a[252:255], v[32:35]
  s_waitcnt vmcnt(8)
  buffer_load_dwordx4 a[228:231], v54, s[16:19], s71 offen offset:128 nt
  s_waitcnt vmcnt(8)
  s_and_b32 s60, s61, 0xffff
  s_mul_i32 s60, s60, 384
  buffer_load_dwordx4 v[184:187], v10, s[8:11], s60 offen nt
  s_waitcnt vmcnt(8)
  buffer_load_dwordx4 a[232:235], v54, s[16:19], s71 offen offset:256 nt
  v_mfma_f32_16x16x32_bf16 v[36:39], v[44:47], a[216:219], v[36:39]
  s_waitcnt vmcnt(8)
  buffer_load_dwordx4 v[188:191], v10, s[8:11], s60 offen offset:128 nt
  s_waitcnt vmcnt(8)
  buffer_load_dwordx4 v[192:195], v11, s[8:11], s60 offen nt
  v_mfma_f32_16x16x32_bf16 v[40:43], v[44:47], a[220:223], v[40:43]
  s_waitcnt vmcnt(8)
  s_mov_b32 s71, 61440
  buffer_load_dwordx4 a[236:239], v54, s[16:19], s71 offen nt
  s_waitcnt vmcnt(8)
  s_lshr_b32 s60, s61, 16
  s_mul_i32 s60, s60, 384
  buffer_load_dwordx4 v[196:199], v10, s[8:11], s60 offen nt
  v_perm_b32 v51, v22, v22, s67
  v_and_b32 v44, v51, v16
  v_and_b32 v45, v51, v17
  v_and_b32 v46, v51, v18
  v_and_b32 v47, v51, v19
  s_nop 1
  v_mfma_f32_16x16x32_bf16 v[32:35], v[44:47], a[224:227], v[32:35]
  s_waitcnt vmcnt(8)
  buffer_load_dwordx4 a[240:243], v54, s[16:19], s71 offen offset:128 nt
  s_waitcnt vmcnt(8)
  v_readlane_b32 s61, v14, 3
  buffer_load_dwordx4 v[200:203], v10, s[8:11], s60 offen offset:128 nt
  s_waitcnt vmcnt(8)
  buffer_load_dwordx4 a[244:247], v54, s[16:19], s71 offen offset:256 nt
  v_mfma_f32_16x16x32_bf16 v[36:39], v[44:47], a[228:231], v[36:39]
  s_waitcnt vmcnt(8)
  buffer_load_dwordx4 v[204:207], v11, s[8:11], s60 offen nt
  s_waitcnt vmcnt(8)
  s_and_b32 s60, s61, 0xffff
  s_mul_i32 s60, s60, 384
  buffer_load_dwordx4 v[208:211], v10, s[8:11], s60 offen nt
  v_mfma_f32_16x16x32_bf16 v[40:43], v[44:47], a[232:235], v[40:43]
  s_waitcnt vmcnt(8)
  s_mov_b32 s71, 73728
  buffer_load_dwordx4 a[248:251], v54, s[16:19], s71 offen nt
  s_waitcnt vmcnt(8)
  buffer_load_dwordx4 v[212:215], v10, s[8:11], s60 offen offset:128 nt
  s_waitcnt vmcnt(8)
  buffer_load_dwordx4 a[252:255], v54, s[16:19], s71 offen offset:128 nt
  v_perm_b32 v51, v22, v22, s68
  v_and_b32 v44, v51, v16
  v_and_b32 v45, v51, v17
  v_and_b32 v46, v51, v18
  v_and_b32 v47, v51, v19
  s_nop 1
  v_mfma_f32_16x16x32_bf16 v[32:35], v[44:47], a[236:239], v[32:35]
  s_waitcnt vmcnt(8)
  buffer_load_dwordx4 v[216:219], v11, s[8:11], s60 offen nt
  s_waitcnt vmcnt(8)
  s_lshr_b32 s60, s61, 16
  s_mul_i32 s60, s60, 384
  buffer_load_dwordx4 v[220:223], v10, s[8:11], s60 offen nt
  v_mfma_f32_16x16x32_bf16 v[36:39], v[44:47], a[240:243], v[36:39]
  s_waitcnt vmcnt(8)
  buffer_load_dwordx4 a[216:219], v54, s[16:19], s71 offen offset:256 nt
  s_waitcnt vmcnt(8)
  v_readlane_b32 s61, v14, 4
  buffer_load_dwordx4 v[224:227], v10, s[8:11], s60 offen offset:128 nt
  v_mfma_f32_16x16x32_bf16 v[40:43], v[44:47], a[244:247], v[40:43]
  s_waitcnt vmcnt(8)
  s_mov_b32 s71, 86016
  buffer_load_dwordx4 a[220:223], v54, s[16:19], s71 offen nt
  s_waitcnt vmcnt(8)
  buffer_load_dwordx4 v[228:231], v11, s[8:11], s60 offen nt
  s_waitcnt vmcnt(8)
  buffer_load_dwordx4 a[224:227], v54, s[16:19], s71 offen offset:128 nt
  v_perm_b32 v51, v23, v23, s67
  v_and_b32 v44, v51, v16
  v_and_b32 v45, v51, v17
  v_and_b32 v46, v51, v18
  v_and_b32 v47, v51, v19
  s_nop 1
  v_mfma_f32_16x16x32_bf16 v[32:35], v[44:47], a[248:251], v[32:35]
  s_waitcnt vmcnt(8)
  s_and_b32 s60, s61, 0xffff
  s_mul_i32 s60, s60, 384
  buffer_load_dwordx4 a[0:3], v10, s[8:11], s60 offen nt
  s_waitcnt vmcnt(8)
  buffer_load_dwordx4 a[4:7], v10, s[8:11], s60 offen offset:128 nt
  v_mfma_f32_16x16x32_bf16 v[36:39], v[44:47], a[252:255], v[36:39]
  s_waitcnt vmcnt(8)
  buffer_load_dwordx4 a[228:231], v54, s[16:19], s71 offen offset:256 nt
  s_waitcnt vmcnt(8)
  buffer_load_dwordx4 a[8:11], v11, s[8:11], s60 offen nt
  s_waitcnt vmcnt(8)
  s_mov_b32 s71, 98304
  buffer_load_dwordx4 a[232:235], v54, s[16:19], s71 offen nt
  v_mfma_f32_16x16x32_bf16 v[40:43], v[44:47], a[216:219], v[40:43]
  s_waitcnt vmcnt(8)
  s_lshr_b32 s60, s61, 16
  s_mul_i32 s60, s60, 384
  buffer_load_dwordx4 a[12:15], v10, s[8:11], s60 offen nt
  s_waitcnt vmcnt(8)
  v_readlane_b32 s61, v14, 5
  buffer_load_dwordx4 a[16:19], v10, s[8:11], s60 offen offset:128 nt
  v_perm_b32 v51, v23, v23, s68
  v_and_b32 v44, v51, v16
  v_and_b32 v45, v51, v17
  v_and_b32 v46, v51, v18
  v_and_b32 v47, v51, v19
  s_nop 1
  v_mfma_f32_16x16x32_bf16 v[32:35], v[44:47], a[220:223], v[32:35]
  s_waitcnt vmcnt(8)
  buffer_load_dwordx4 a[236:239], v54, s[16:19], s71 offen offset:128 nt
  s_waitcnt vmcnt(8)
  buffer_load_dwordx4 a[20:23], v11, s[8:11], s60 offen nt
  v_mfma_f32_16x16x32_bf16 v[36:39], v[44:47], a[224:227], v[36:39]
  s_waitcnt vmcnt(8)
  buffer_load_dwordx4 a[240:243], v54, s[16:19], s71 offen offset:256 nt
  s_waitcnt vmcnt(8)
  s_and_b32 s60, s61, 0xffff
  s_mul_i32 s60, s60, 384
  buffer_load_dwordx4 a[24:27], v10, s[8:11], s60 offen nt
  s_waitcnt vmcnt(8)
  s_mov_b32 s71, 110592
  buffer_load_dwordx4 a[244:247], v54, s[16:19], s71 offen nt
  v_mfma_f32_16x16x32_bf16 v[40:43], v[44:47], a[228:231], v[40:43]
  s_waitcnt vmcnt(8)
  buffer_load_dwordx4 a[28:31], v10, s[8:11], s60 offen offset:128 nt
  s_waitcnt vmcnt(8)
  buffer_load_dwordx4 a[32:35], v11, s[8:11], s60 offen nt
  v_perm_b32 v51, v24, v24, s67
  v_and_b32 v44, v51, v16
  v_and_b32 v45, v51, v17
  v_and_b32 v46, v51, v18
  v_and_b32 v47, v51, v19
  s_nop 1
  v_mfma_f32_16x16x32_bf16 v[32:35], v[44:47], a[232:235], v[32:35]
  s_waitcnt vmcnt(8)
  buffer_load_dwordx4 a[248:251], v54, s[16:19], s71 offen offset:128 nt
  s_waitcnt vmcnt(8)
  s_lshr_b32 s60, s61, 16
  s_mul_i32 s60, s60, 384
  buffer_load_dwordx4 a[36:39], v10, s[8:11], s60 offen nt
  s_waitcnt vmcnt(8)
  buffer_load_dwordx4 a[252:255], v54, s[16:19], s71 offen offset:256 nt
  v_mfma_f32_16x16x32_bf16 v[36:39], v[44:47], a[236:239], v[36:39]
  s_waitcnt vmcnt(8)
  v_readlane_b32 s61, v14, 6
  buffer_load_dwordx4 a[40:43], v10, s[8:11], s60 offen offset:128 nt
  s_waitcnt vmcnt(8)
  buffer_load_dwordx4 a[44:47], v11, s[8:11], s60 offen nt
  v_mfma_f32_16x16x32_bf16 v[40:43], v[44:47], a[240:243], v[40:43]
  s_waitcnt vmcnt(8)
  s_mov_b32 s71, 122880
  buffer_load_dwordx4 a[216:219], v54, s[16:19], s71 offen nt
  s_waitcnt vmcnt(8)
  s_and_b32 s60, s61, 0xffff
  s_mul_i32 s60, s60, 384
  buffer_load_dwordx4 a[48:51], v10, s[8:11], s60 offen nt
  v_perm_b32 v51, v24, v24, s68
  v_and_b32 v44, v51, v16
  v_and_b32 v45, v51, v17
  v_and_b32 v46, v51, v18
  v_and_b32 v47, v51, v19
  s_nop 1
  v_mfma_f32_16x16x32_bf16 v[32:35], v[44:47], a[244:247], v[32:35]
  s_waitcnt vmcnt(8)
  buffer_load_dwordx4 a[220:223], v54, s[16:19], s71 offen offset:128 nt
  s_waitcnt vmcnt(8)
  buffer_load_dwordx4 a[52:55], v10, s[8:11], s60 offen offset:128 nt
  s_waitcnt vmcnt(8)
  buffer_load_dwordx4 a[224:227], v54, s[16:19], s71 offen offset:256 nt
  v_mfma_f32_16x16x32_bf16 v[36:39], v[44:47], a[248:251], v[36:39]
  s_waitcnt vmcnt(8)
  buffer_load_dwordx4 a[56:59], v11, s[8:11], s60 offen nt
  s_waitcnt vmcnt(8)
  s_lshr_b32 s60, s61, 16
  s_mul_i32 s60, s60, 384
  buffer_load_dwordx4 a[60:63], v10, s[8:11], s60 offen nt
  v_mfma_f32_16x16x32_bf16 v[40:43], v[44:47], a[252:255], v[40:43]
  s_waitcnt vmcnt(8)
  s_mov_b32 s71, 135168
  buffer_load_dwordx4 a[228:231], v54, s[16:19], s71 offen nt
  s_waitcnt vmcnt(8)
  v_readlane_b32 s61, v14, 7
  buffer_load_dwordx4 a[64:67], v10, s[8:11], s60 offen offset:128 nt
  s_waitcnt vmcnt(8)
  buffer_load_dwordx4 a[232:235], v54, s[16:19], s71 offen offset:128 nt
  v_perm_b32 v51, v25, v25, s67
  v_and_b32 v44, v51, v16
  v_and_b32 v45, v51, v17
  v_and_b32 v46, v51, v18
  v_and_b32 v47, v51, v19
  s_nop 1
  v_mfma_f32_16x16x32_bf16 v[32:35], v[44:47], a[216:219], v[32:35]
  s_waitcnt vmcnt(8)
  buffer_load_dwordx4 a[68:71], v11, s[8:11], s60 offen nt
  s_waitcnt vmcnt(8)
  s_and_b32 s60, s61, 0xffff
  s_mul_i32 s60, s60, 384
  buffer_load_dwordx4 a[72:75], v10, s[8:11], s60 offen nt
  v_mfma_f32_16x16x32_bf16 v[36:39], v[44:47], a[220:223], v[36:39]
  s_waitcnt vmcnt(8)
  buffer_load_dwordx4 a[236:239], v54, s[16:19], s71 offen offset:256 nt
  s_waitcnt vmcnt(8)
  buffer_load_dwordx4 a[76:79], v10, s[8:11], s60 offen offset:128 nt
  v_mfma_f32_16x16x32_bf16 v[40:43], v[44:47], a[224:227], v[40:43]
  s_waitcnt vmcnt(8)
  s_mov_b32 s71, 147456
  buffer_load_dwordx4 a[240:243], v54, s[16:19], s71 offen nt
  s_waitcnt vmcnt(8)
  buffer_load_dwordx4 a[80:83], v11, s[8:11], s60 offen nt
  s_waitcnt vmcnt(8)
  buffer_load_dwordx4 a[244:247], v54, s[16:19], s71 offen offset:128 nt
  v_perm_b32 v51, v25, v25, s68
  v_and_b32 v44, v51, v16
  v_and_b32 v45, v51, v17
  v_and_b32 v46, v51, v18
  v_and_b32 v47, v51, v19
  s_nop 1
  v_mfma_f32_16x16x32_bf16 v[32:35], v[44:47], a[228:231], v[32:35]
  s_waitcnt vmcnt(8)
  s_lshr_b32 s60, s61, 16
  s_mul_i32 s60, s60, 384
  buffer_load_dwordx4 a[84:87], v10, s[8:11], s60 offen nt
  s_waitcnt vmcnt(8)
  v_readlane_b32 s61, v14, 8
  buffer_load_dwordx4 a[88:91], v10, s[8:11], s60 offen offset:128 nt
  v_mfma_f32_16x16x32_bf16 v[36:39], v[44:47], a[232:235], v[36:39]
  s_waitcnt vmcnt(8)
  buffer_load_dwordx4 a[248:251], v54, s[16:19], s71 offen offset:256 nt
  s_waitcnt vmcnt(8)
  buffer_load_dwordx4 a[92:95], v11, s[8:11], s60 offen nt
  s_waitcnt vmcnt(8)
  s_mov_b32 s71, 159744
  buffer_load_dwordx4 a[252:255], v54, s[16:19], s71 offen nt
  v_mfma_f32_16x16x32_bf16 v[40:43], v[44:47], a[236:239], v[40:43]
  s_waitcnt vmcnt(8)
  s_and_b32 s60, s61, 0xffff
  s_mul_i32 s60, s60, 384
  buffer_load_dwordx4 a[96:99], v10, s[8:11], s60 offen nt
  s_waitcnt vmcnt(8)
  buffer_load_dwordx4 a[100:103], v10, s[8:11], s60 offen offset:128 nt
  v_perm_b32 v51, v26, v26, s67
  v_and_b32 v44, v51, v16
  v_and_b32 v45, v51, v17
  v_and_b32 v46, v51, v18
  v_and_b32 v47, v51, v19
  s_nop 1
  v_mfma_f32_16x16x32_bf16 v[32:35], v[44:47], a[240:243], v[32:35]
  s_waitcnt vmcnt(8)
  buffer_load_dwordx4 a[216:219], v54, s[16:19], s71 offen offset:128 nt
  s_waitcnt vmcnt(8)
  buffer_load_dwordx4 a[104:107], v11, s[8:11], s60 offen nt
  v_mfma_f32_16x16x32_bf16 v[36:39], v[44:47], a[244:247], v[36:39]
  s_waitcnt vmcnt(8)
  buffer_load_dwordx4 a[220:223], v54, s[16:19], s71 offen offset:256 nt
  s_waitcnt vmcnt(8)
  s_lshr_b32 s60, s61, 16
  s_mul_i32 s60, s60, 384
  buffer_load_dwordx4 a[108:111], v10, s[8:11], s60 offen nt
  s_waitcnt vmcnt(8)
  s_mov_b32 s71, 172032
  buffer_load_dwordx4 a[224:227], v54, s[16:19], s71 offen nt
  v_mfma_f32_16x16x32_bf16 v[40:43], v[44:47], a[248:251], v[40:43]
  s_waitcnt vmcnt(8)
  v_readlane_b32 s61, v14, 9
  buffer_load_dwordx4 a[112:115], v10, s[8:11], s60 offen offset:128 nt
  s_waitcnt vmcnt(8)
  buffer_load_dwordx4 a[116:119], v11, s[8:11], s60 offen nt
  v_perm_b32 v51, v26, v26, s68
  v_and_b32 v44, v51, v16
  v_and_b32 v45, v51, v17
  v_and_b32 v46, v51, v18
  v_and_b32 v47, v51, v19
  s_nop 1
  v_mfma_f32_16x16x32_bf16 v[32:35], v[44:47], a[252:255], v[32:35]
  s_waitcnt vmcnt(8)
  buffer_load_dwordx4 a[228:231], v54, s[16:19], s71 offen offset:128 nt
  s_waitcnt vmcnt(8)
  s_and_b32 s60, s61, 0xffff
  s_mul_i32 s60, s60, 384
  buffer_load_dwordx4 a[120:123], v10, s[8:11], s60 offen nt
  s_waitcnt vmcnt(8)
  buffer_load_dwordx4 a[232:235], v54, s[16:19], s71 offen offset:256 nt
  v_mfma_f32_16x16x32_bf16 v[36:39], v[44:47], a[216:219], v[36:39]
  s_waitcnt vmcnt(8)
  buffer_load_dwordx4 a[124:127], v10, s[8:11], s60 offen offset:128 nt
  s_waitcnt vmcnt(8)
  buffer_load_dwordx4 a[128:131], v11, s[8:11], s60 offen nt
  v_mfma_f32_16x16x32_bf16 v[40:43], v[44:47], a[220:223], v[40:43]
  s_waitcnt vmcnt(8)
  s_mov_b32 s71, 184320
  buffer_load_dwordx4 a[236:239], v54, s[16:19], s71 offen nt
  s_waitcnt vmcnt(8)
  s_lshr_b32 s60, s61, 16
  s_mul_i32 s60, s60, 384
  buffer_load_dwordx4 a[132:135], v10, s[8:11], s60 offen nt
  v_perm_b32 v51, v27, v27, s67
  v_and_b32 v44, v51, v16
  v_and_b32 v45, v51, v17
  v_and_b32 v46, v51, v18
  v_and_b32 v47, v51, v19
  s_nop 1
  v_mfma_f32_16x16x32_bf16 v[32:35], v[44:47], a[224:227], v[32:35]
  s_waitcnt vmcnt(8)
  buffer_load_dwordx4 a[240:243], v54, s[16:19], s71 offen offset:128 nt
  s_waitcnt vmcnt(8)
  v_readlane_b32 s61, v14, 10
  buffer_load_dwordx4 a[136:139], v10, s[8:11], s60 offen offset:128 nt
  s_waitcnt vmcnt(8)
  buffer_load_dwordx4 a[244:247], v54, s[16:19], s71 offen offset:256 nt
  v_mfma_f32_16x16x32_bf16 v[36:39], v[44:47], a[228:231], v[36:39]
  s_waitcnt vmcnt(8)
  buffer_load_dwordx4 a[140:143], v11, s[8:11], s60 offen nt
  s_waitcnt vmcnt(8)
  s_and_b32 s60, s61, 0xffff
  s_mul_i32 s60, s60, 384
  buffer_load_dwordx4 a[144:147], v10, s[8:11], s60 offen nt
  v_mfma_f32_16x16x32_bf16 v[40:43], v[44:47], a[232:235], v[40:43]
  s_waitcnt vmcnt(8)
  s_mov_b32 s71, 196608
  buffer_load_dwordx4 a[248:251], v54, s[16:19], s71 offen nt
  s_waitcnt vmcnt(8)
  buffer_load_dwordx4 a[148:151], v10, s[8:11], s60 offen offset:128 nt
  s_waitcnt vmcnt(8)
  buffer_load_dwordx4 a[252:255], v54, s[16:19], s71 offen offset:128 nt
  v_perm_b32 v51, v27, v27, s68
  v_and_b32 v44, v51, v16
  v_and_b32 v45, v51, v17
  v_and_b32 v46, v51, v18
  v_and_b32 v47, v51, v19
  s_nop 1
  v_mfma_f32_16x16x32_bf16 v[32:35], v[44:47], a[236:239], v[32:35]
  s_waitcnt vmcnt(8)
  buffer_load_dwordx4 a[152:155], v11, s[8:11], s60 offen nt
  s_waitcnt vmcnt(8)
  s_lshr_b32 s60, s61, 16
  s_mul_i32 s60, s60, 384
  buffer_load_dwordx4 a[156:159], v10, s[8:11], s60 offen nt
  v_mfma_f32_16x16x32_bf16 v[36:39], v[44:47], a[240:243], v[36:39]
  s_waitcnt vmcnt(8)
  buffer_load_dwordx4 a[216:219], v54, s[16:19], s71 offen offset:256 nt
  s_waitcnt vmcnt(8)
  v_readlane_b32 s61, v14, 11
  buffer_load_dwordx4 a[160:163], v10, s[8:11], s60 offen offset:128 nt
  v_mfma_f32_16x16x32_bf16 v[40:43], v[44:47], a[244:247], v[40:43]
  s_waitcnt vmcnt(8)
  s_mov_b32 s71, 208896
  buffer_load_dwordx4 a[220:223], v54, s[16:19], s71 offen nt
  s_waitcnt vmcnt(8)
  buffer_load_dwordx4 a[164:167], v11, s[8:11], s60 offen nt
  s_waitcnt vmcnt(8)
  buffer_load_dwordx4 a[224:227], v54, s[16:19], s71 offen offset:128 nt
  v_perm_b32 v51, v28, v28, s67
  v_and_b32 v44, v51, v16
  v_and_b32 v45, v51, v17
  v_and_b32 v46, v51, v18
  v_and_b32 v47, v51, v19
  s_nop 1
  v_mfma_f32_16x16x32_bf16 v[32:35], v[44:47], a[248:251], v[32:35]
  s_waitcnt vmcnt(8)
  s_and_b32 s60, s61, 0xffff
  s_mul_i32 s60, s60, 384
  buffer_load_dwordx4 a[168:171], v10, s[8:11], s60 offen nt
  s_waitcnt vmcnt(8)
  buffer_load_dwordx4 a[172:175], v10, s[8:11], s60 offen offset:128 nt
  v_mfma_f32_16x16x32_bf16 v[36:39], v[44:47], a[252:255], v[36:39]
  s_waitcnt vmcnt(8)
  buffer_load_dwordx4 a[228:231], v54, s[16:19], s71 offen offset:256 nt
  s_waitcnt vmcnt(8)
  buffer_load_dwordx4 a[176:179], v11, s[8:11], s60 offen nt
  s_waitcnt vmcnt(8)
  s_mov_b32 s71, 221184
  buffer_load_dwordx4 a[232:235], v54, s[16:19], s71 offen nt
  v_mfma_f32_16x16x32_bf16 v[40:43], v[44:47], a[216:219], v[40:43]
  s_waitcnt vmcnt(8)
  s_lshr_b32 s60, s61, 16
  s_mul_i32 s60, s60, 384
  buffer_load_dwordx4 a[180:183], v10, s[8:11], s60 offen nt
  s_waitcnt vmcnt(8)
  v_readlane_b32 s61, v14, 12
  buffer_load_dwordx4 a[184:187], v10, s[8:11], s60 offen offset:128 nt
  v_perm_b32 v51, v28, v28, s68
  v_and_b32 v44, v51, v16
  v_and_b32 v45, v51, v17
  v_and_b32 v46, v51, v18
  v_and_b32 v47, v51, v19
  s_nop 1
  v_mfma_f32_16x16x32_bf16 v[32:35], v[44:47], a[220:223], v[32:35]
  s_waitcnt vmcnt(8)
  buffer_load_dwordx4 a[236:239], v54, s[16:19], s71 offen offset:128 nt
  s_waitcnt vmcnt(8)
  buffer_load_dwordx4 a[188:191], v11, s[8:11], s60 offen nt
  v_mfma_f32_16x16x32_bf16 v[36:39], v[44:47], a[224:227], v[36:39]
  s_waitcnt vmcnt(8)
  buffer_load_dwordx4 a[240:243], v54, s[16:19], s71 offen offset:256 nt
  s_waitcnt vmcnt(8)
  s_and_b32 s60, s61, 0xffff
  s_mul_i32 s60, s60, 384
  buffer_load_dwordx4 a[192:195], v10, s[8:11], s60 offen nt
  s_waitcnt vmcnt(8)
  s_mov_b32 s71, 233472
  buffer_load_dwordx4 a[244:247], v54, s[16:19], s71 offen nt
  v_mfma_f32_16x16x32_bf16 v[40:43], v[44:47], a[228:231], v[40:43]
  s_waitcnt vmcnt(8)
  buffer_load_dwordx4 a[196:199], v10, s[8:11], s60 offen offset:128 nt
  s_waitcnt vmcnt(8)
  buffer_load_dwordx4 a[200:203], v11, s[8:11], s60 offen nt
  v_perm_b32 v51, v29, v29, s67
  v_and_b32 v44, v51, v16
  v_and_b32 v45, v51, v17
  v_and_b32 v46, v51, v18
  v_and_b32 v47, v51, v19
  s_nop 1
  v_mfma_f32_16x16x32_bf16 v[32:35], v[44:47], a[232:235], v[32:35]
  s_waitcnt vmcnt(8)
  buffer_load_dwordx4 a[248:251], v54, s[16:19], s71 offen offset:128 nt
  s_waitcnt vmcnt(8)
  s_lshr_b32 s60, s61, 16
  s_mul_i32 s60, s60, 384
  buffer_load_dwordx4 a[204:207], v10, s[8:11], s60 offen nt
  s_waitcnt vmcnt(8)
  buffer_load_dwordx4 a[252:255], v54, s[16:19], s71 offen offset:256 nt
  v_mfma_f32_16x16x32_bf16 v[36:39], v[44:47], a[236:239], v[36:39]
  s_waitcnt vmcnt(8)
  v_readlane_b32 s61, v14, 13
  buffer_load_dwordx4 a[208:211], v10, s[8:11], s60 offen offset:128 nt
  s_waitcnt vmcnt(8)
  buffer_load_dwordx4 a[212:215], v11, s[8:11], s60 offen nt
  v_mfma_f32_16x16x32_bf16 v[40:43], v[44:47], a[240:243], v[40:43]
  s_waitcnt vmcnt(8)
  s_and_b32 s60, s61, 0xffff
  s_mul_i32 s60, s60, 384
  buffer_load_dwordx4 v[64:67], v10, s[8:11], s60 offen nt
  s_waitcnt vmcnt(8)
  buffer_load_dwordx4 v[68:71], v10, s[8:11], s60 offen offset:128 nt
  v_perm_b32 v51, v29, v29, s68
  v_and_b32 v44, v51, v16
  v_and_b32 v45, v51, v17
  v_and_b32 v46, v51, v18
  v_and_b32 v47, v51, v19
  s_nop 1
  v_mfma_f32_16x16x32_bf16 v[32:35], v[44:47], a[244:247], v[32:35]
  s_waitcnt vmcnt(8)
  buffer_load_dwordx4 v[72:75], v11, s[8:11], s60 offen nt
  s_waitcnt vmcnt(8)
  s_lshr_b32 s60, s61, 16
  s_mul_i32 s60, s60, 384
  buffer_load_dwordx4 v[76:79], v10, s[8:11], s60 offen nt
  s_waitcnt vmcnt(8)
  v_readlane_b32 s61, v14, 14
  buffer_load_dwordx4 v[80:83], v10, s[8:11], s60 offen offset:128 nt
  v_mfma_f32_16x16x32_bf16 v[36:39], v[44:47], a[248:251], v[36:39]
  s_waitcnt vmcnt(8)
  buffer_load_dwordx4 v[84:87], v11, s[8:11], s60 offen nt
  s_waitcnt vmcnt(8)
  s_and_b32 s60, s61, 0xffff
  s_mul_i32 s60, s60, 384
  buffer_load_dwordx4 v[88:91], v10, s[8:11], s60 offen nt
  v_mfma_f32_16x16x32_bf16 v[40:43], v[44:47], a[252:255], v[40:43]
  v_lshlrev_b32 v56, 1, v1
  v_bfe_u32 v57, v0, 4, 1
  v_lshl_add_u32 v56, v57, 4, v56
  v_mul_u32_u24 v57, 768, v3
  v_add_u32 v56, v56, v57
  s_mul_i32 s69, s56, 1536
  v_add_u32 v56, s69, v56
  s_mov_b32 exec_lo, 0x00ff00ff
  s_mov_b32 exec_hi, 0xff00ff00
  ds_write_b128 v56, v[32:35] offset:0
  ds_write_b128 v56, v[36:39] offset:256
  ds_write_b128 v56, v[40:43] offset:512
  s_mov_b64 exec, -1
  v_lshlrev_b32 v57, 2, v0
  s_waitcnt lgkmcnt(0)
  s_barrier
  ds_read_b32 v232, v57 offset:0
  ds_read_b32 v233, v57 offset:768
  ds_read_b32 v234, v57 offset:1536
  ds_read_b32 v235, v57 offset:2304
  ds_read_b32 v236, v57 offset:3072
  ds_read_b32 v237, v57 offset:3840
  ds_read_b32 v238, v57 offset:4608
  ds_read_b32 v239, v57 offset:5376
  ds_read_b32 v240, v57 offset:256
  ds_read_b32 v241, v57 offset:1024
  ds_read_b32 v242, v57 offset:1792
  ds_read_b32 v243, v57 offset:2560
  ds_read_b32 v244, v57 offset:3328
  ds_read_b32 v245, v57 offset:4096
  ds_read_b32 v246, v57 offset:4864
  ds_read_b32 v247, v57 offset:5632
  ds_read_b32 v248, v57 offset:512
  ds_read_b32 v249, v57 offset:1280
  ds_read_b32 v250, v57 offset:2048
  ds_read_b32 v251, v57 offset:2816
  ds_read_b32 v252, v57 offset:3584
  ds_read_b32 v253, v57 offset:4352
  ds_read_b32 v254, v57 offset:5120
  ds_read_b32 v255, v57 offset:5888
  v_mov_b32 v32, 0
  v_mov_b32 v33, 0
  v_mov_b32 v34, 0
  v_mov_b32 v35, 0
  v_mov_b32 v36, 0
  v_mov_b32 v37, 0
  v_mov_b32 v38, 0
  v_mov_b32 v39, 0
  v_mov_b32 v40, 0
  v_mov_b32 v41, 0
  v_mov_b32 v42, 0
  v_mov_b32 v43, 0
  s_waitcnt vmcnt(8)
  buffer_load_dwordx4 v[92:95], v10, s[8:11], s60 offen offset:128 nt
  s_waitcnt vmcnt(8)
  buffer_load_dwordx4 v[96:99], v11, s[8:11], s60 offen nt
  s_waitcnt vmcnt(8)
  s_lshr_b32 s60, s61, 16
  s_mul_i32 s60, s60, 384
  buffer_load_dwordx4 v[100:103], v10, s[8:11], s60 offen nt
  s_waitcnt vmcnt(8)
  v_readlane_b32 s61, v14, 15
  buffer_load_dwordx4 v[104:107], v10, s[8:11], s60 offen offset:128 nt
  s_mul_i32 s69, s56, 384
  v_lshlrev_b32 v58, 1, v0
  v_add_u32 v58, s69, v58
  v_add_u32 v59, s69, v1
  s_waitcnt lgkmcnt(0)
  v_add_f32 v232, v232, v233
  v_add_f32 v232, v232, v234
  v_add_f32 v232, v232, v235
  v_add_f32 v232, v232, v236
  v_add_f32 v232, v232, v237
  v_add_f32 v232, v232, v238
  v_add_f32 v232, v232, v239
  v_cvt_pk_bf16_f32 v232, v232, v232
  ds_write_b16 v58, v232 offset:6144
  v_add_f32 v240, v240, v241
  v_add_f32 v240, v240, v242
  v_add_f32 v240, v240, v243
  v_add_f32 v240, v240, v244
  v_add_f32 v240, v240, v245
  v_add_f32 v240, v240, v246
  v_add_f32 v240, v240, v247
  v_cvt_pk_bf16_f32 v240, v240, v240
  ds_write_b16 v58, v240 offset:6272
  v_add_f32 v248, v248, v249
  v_add_f32 v248, v248, v250
  v_add_f32 v248, v248, v251
  v_add_f32 v248, v248, v252
  v_add_f32 v248, v248, v253
  v_add_f32 v248, v248, v254
  v_add_f32 v248, v248, v255
  v_cvt_pk_bf16_f32 v248, v248, v248
  ds_write_b16 v58, v248 offset:6400
  v_add_u32 v60, v59, v8
  v_add_u32 v61, v59, v9
  s_waitcnt lgkmcnt(0)
  ds_read_b128 v[20:23], v60 offset:6144
  ds_read_b128 v[24:27], v60 offset:6272
  ds_read_b128 v[28:31], v61 offset:6144
  s_mul_i32 s69, s56, 4224
  s_add_u32 s69, s69, 14176
  v_mul_u32_u24 v252, 528, v2
  v_add_u32 v252, s69, v252
  s_waitcnt lgkmcnt(0)
  v_dot2_f32_bf16 v48, v64, v20, 0
  v_dot2_f32_bf16 v48, v65, v21, v48
  v_dot2_f32_bf16 v48, v66, v22, v48
  v_dot2_f32_bf16 v48, v67, v23, v48
  v_dot2_f32_bf16 v48, v68, v24, v48
  v_dot2_f32_bf16 v48, v69, v25, v48
  v_dot2_f32_bf16 v48, v70, v26, v48
  v_dot2_f32_bf16 v48, v71, v27, v48
  s_waitcnt vmcnt(7)
  buffer_load_dwordx4 v[108:111], v11, s[8:11], s60 offen nt
  v_dot2_f32_bf16 v48, v72, v28, v48
  v_dot2_f32_bf16 v48, v73, v29, v48
  v_dot2_f32_bf16 v48, v74, v30, v48
  v_dot2_f32_bf16 v48, v75, v31, v48
  s_nop 2
  v_add_f32_dpp v48, v48, v48 quad_perm:[1,0,3,2] row_mask:0xf bank_mask:0xf
  s_nop 1
  v_add_f32_dpp v48, v48, v48 quad_perm:[2,3,0,1] row_mask:0xf bank_mask:0xf
  s_nop 1
  v_add_f32_dpp v48, v48, v48 row_half_mirror row_mask:0xf bank_mask:0xf
  v_cvt_pk_bf16_f32 v48, v48, v48
  v_and_b32 v48, s72, v48
  v_mul_f32 v48, s66, v48
  v_cvt_pk_bf16_f32 v48, v48, v48
  v_and_b32 v244, s72, v48
  ds_write_b32 v252, v244 offset:112
  v_accvgpr_read_b32 v232, a0
  v_accvgpr_read_b32 v233, a1
  v_accvgpr_read_b32 v234, a2
  v_accvgpr_read_b32 v235, a3
  v_dot2_f32_bf16 v48, v232, v20, 0
  v_dot2_f32_bf16 v48, v233, v21, v48
  v_dot2_f32_bf16 v48, v234, v22, v48
  v_dot2_f32_bf16 v48, v235, v23, v48
  v_accvgpr_read_b32 v236, a4
  v_accvgpr_read_b32 v237, a5
  v_accvgpr_read_b32 v238, a6
  v_accvgpr_read_b32 v239, a7
  v_dot2_f32_bf16 v48, v236, v24, v48
  v_dot2_f32_bf16 v48, v237, v25, v48
  v_dot2_f32_bf16 v48, v238, v26, v48
  v_dot2_f32_bf16 v48, v239, v27, v48
  v_accvgpr_read_b32 v240, a8
  v_accvgpr_read_b32 v241, a9
  v_accvgpr_read_b32 v242, a10
  v_accvgpr_read_b32 v243, a11
  v_dot2_f32_bf16 v48, v240, v28, v48
  v_dot2_f32_bf16 v48, v241, v29, v48
  v_dot2_f32_bf16 v48, v242, v30, v48
  v_dot2_f32_bf16 v48, v243, v31, v48
  s_nop 2
  v_add_f32_dpp v48, v48, v48 quad_perm:[1,0,3,2] row_mask:0xf bank_mask:0xf
  s_nop 1
  v_add_f32_dpp v48, v48, v48 quad_perm:[2,3,0,1] row_mask:0xf bank_mask:0xf
  s_nop 1
  v_add_f32_dpp v48, v48, v48 row_half_mirror row_mask:0xf bank_mask:0xf
  v_cvt_pk_bf16_f32 v48, v48, v48
  v_and_b32 v48, s72, v48
  v_mul_f32 v48, s66, v48
  v_cvt_pk_bf16_f32 v48, v48, v48
  v_and_b32 v49, s72, v48
  ds_write_b32 v252, v49 offset:40
  v_accvgpr_read_b32 v232, a12
  v_accvgpr_read_b32 v233, a13
  v_accvgpr_read_b32 v234, a14
  v_accvgpr_read_b32 v235, a15
  v_dot2_f32_bf16 v48, v232, v20, 0
  v_dot2_f32_bf16 v48, v233, v21, v48
  v_dot2_f32_bf16 v48, v234, v22, v48
  v_dot2_f32_bf16 v48, v235, v23, v48
  v_accvgpr_read_b32 v236, a16
  v_accvgpr_read_b32 v237, a17
  v_accvgpr_read_b32 v238, a18
  v_accvgpr_read_b32 v239, a19
  v_dot2_f32_bf16 v48, v236, v24, v48
  v_dot2_f32_bf16 v48, v237, v25, v48
  v_dot2_f32_bf16 v48, v238, v26, v48
  v_dot2_f32_bf16 v48, v239, v27, v48
  v_accvgpr_read_b32 v240, a20
  v_accvgpr_read_b32 v241, a21
  v_accvgpr_read_b32 v242, a22
  v_accvgpr_read_b32 v243, a23
  v_dot2_f32_bf16 v48, v240, v28, v48
  v_dot2_f32_bf16 v48, v241, v29, v48
  v_dot2_f32_bf16 v48, v242, v30, v48
  v_dot2_f32_bf16 v48, v243, v31, v48
  s_nop 2
  v_add_f32_dpp v48, v48, v48 quad_perm:[1,0,3,2] row_mask:0xf bank_mask:0xf
  s_nop 1
  v_add_f32_dpp v48, v48, v48 quad_perm:[2,3,0,1] row_mask:0xf bank_mask:0xf
  s_nop 1
  v_add_f32_dpp v48, v48, v48 row_half_mirror row_mask:0xf bank_mask:0xf
  v_cvt_pk_bf16_f32 v48, v48, v48
  v_and_b32 v48, s72, v48
  v_mul_f32 v48, s66, v48
  v_cvt_pk_bf16_f32 v48, v48, v48
  v_and_b32 v49, s72, v48
  ds_write_b32 v252, v49 offset:44
  v_dot2_f32_bf16 v48, v76, v20, 0
  v_dot2_f32_bf16 v48, v77, v21, v48
  v_dot2_f32_bf16 v48, v78, v22, v48
  v_dot2_f32_bf16 v48, v79, v23, v48
  s_waitcnt vmcnt(7)
  s_and_b32 s60, s61, 0xffff
  s_mul_i32 s60, s60, 384
  buffer_load_dwordx4 v[64:67], v10, s[8:11], s60 offen nt
  v_dot2_f32_bf16 v48, v80, v24, v48
  v_dot2_f32_bf16 v48, v81, v25, v48
  v_dot2_f32_bf16 v48, v82, v26, v48
  v_dot2_f32_bf16 v48, v83, v27, v48
  s_waitcnt vmcnt(7)
  buffer_load_dwordx4 v[68:71], v10, s[8:11], s60 offen offset:128 nt
  v_dot2_f32_bf16 v48, v84, v28, v48
  v_dot2_f32_bf16 v48, v85, v29, v48
  v_dot2_f32_bf16 v48, v86, v30, v48
  v_dot2_f32_bf16 v48, v87, v31, v48
  s_nop 2
  v_add_f32_dpp v48, v48, v48 quad_perm:[1,0,3,2] row_mask:0xf bank_mask:0xf
  s_nop 1
  v_add_f32_dpp v48, v48, v48 quad_perm:[2,3,0,1] row_mask:0xf bank_mask:0xf
  s_nop 1
  v_add_f32_dpp v48, v48, v48 row_half_mirror row_mask:0xf bank_mask:0xf
  v_cvt_pk_bf16_f32 v48, v48, v48
  v_and_b32 v48, s72, v48
  v_mul_f32 v48, s66, v48
  v_cvt_pk_bf16_f32 v48, v48, v48
  v_and_b32 v245, s72, v48
  ds_write_b32 v252, v245 offset:116
  v_accvgpr_read_b32 v232, a24
  v_accvgpr_read_b32 v233, a25
  v_accvgpr_read_b32 v234, a26
  v_accvgpr_read_b32 v235, a27
  v_dot2_f32_bf16 v48, v232, v20, 0
  v_dot2_f32_bf16 v48, v233, v21, v48
  v_dot2_f32_bf16 v48, v234, v22, v48
  v_dot2_f32_bf16 v48, v235, v23, v48
  v_accvgpr_read_b32 v236, a28
  v_accvgpr_read_b32 v237, a29
  v_accvgpr_read_b32 v238, a30
  v_accvgpr_read_b32 v239, a31
  v_dot2_f32_bf16 v48, v236, v24, v48
  v_dot2_f32_bf16 v48, v237, v25, v48
  v_dot2_f32_bf16 v48, v238, v26, v48
  v_dot2_f32_bf16 v48, v239, v27, v48
  v_accvgpr_read_b32 v240, a32
  v_accvgpr_read_b32 v241, a33
  v_accvgpr_read_b32 v242, a34
  v_accvgpr_read_b32 v243, a35
  v_dot2_f32_bf16 v48, v240, v28, v48
  v_dot2_f32_bf16 v48, v241, v29, v48
  v_dot2_f32_bf16 v48, v242, v30, v48
  v_dot2_f32_bf16 v48, v243, v31, v48
  s_nop 2
  v_add_f32_dpp v48, v48, v48 quad_perm:[1,0,3,2] row_mask:0xf bank_mask:0xf
  s_nop 1
  v_add_f32_dpp v48, v48, v48 quad_perm:[2,3,0,1] row_mask:0xf bank_mask:0xf
  s_nop 1
  v_add_f32_dpp v48, v48, v48 row_half_mirror row_mask:0xf bank_mask:0xf
  v_cvt_pk_bf16_f32 v48, v48, v48
  v_and_b32 v48, s72, v48
  v_mul_f32 v48, s66, v48
  v_cvt_pk_bf16_f32 v48, v48, v48
  v_and_b32 v49, s72, v48
  ds_write_b32 v252, v49 offset:48
  v_accvgpr_read_b32 v232, a36
  v_accvgpr_read_b32 v233, a37
  v_accvgpr_read_b32 v234, a38
  v_accvgpr_read_b32 v235, a39
  v_dot2_f32_bf16 v48, v232, v20, 0
  v_dot2_f32_bf16 v48, v233, v21, v48
  v_dot2_f32_bf16 v48, v234, v22, v48
  v_dot2_f32_bf16 v48, v235, v23, v48
  v_accvgpr_read_b32 v236, a40
  v_accvgpr_read_b32 v237, a41
  v_accvgpr_read_b32 v238, a42
  v_accvgpr_read_b32 v239, a43
  v_dot2_f32_bf16 v48, v236, v24, v48
  v_dot2_f32_bf16 v48, v237, v25, v48
  v_dot2_f32_bf16 v48, v238, v26, v48
  v_dot2_f32_bf16 v48, v239, v27, v48
  v_accvgpr_read_b32 v240, a44
  v_accvgpr_read_b32 v241, a45
  v_accvgpr_read_b32 v242, a46
  v_accvgpr_read_b32 v243, a47
  v_dot2_f32_bf16 v48, v240, v28, v48
  v_dot2_f32_bf16 v48, v241, v29, v48
  v_dot2_f32_bf16 v48, v242, v30, v48
  v_dot2_f32_bf16 v48, v243, v31, v48
  s_nop 2
  v_add_f32_dpp v48, v48, v48 quad_perm:[1,0,3,2] row_mask:0xf bank_mask:0xf
  s_nop 1
  v_add_f32_dpp v48, v48, v48 quad_perm:[2,3,0,1] row_mask:0xf bank_mask:0xf
  s_nop 1
  v_add_f32_dpp v48, v48, v48 row_half_mirror row_mask:0xf bank_mask:0xf
  v_cvt_pk_bf16_f32 v48, v48, v48
  v_and_b32 v48, s72, v48
  v_mul_f32 v48, s66, v48
  v_cvt_pk_bf16_f32 v48, v48, v48
  v_and_b32 v49, s72, v48
  ds_write_b32 v252, v49 offset:52
  s_waitcnt vmcnt(7)
  s_mov_b32 s71, 0
  buffer_load_dwordx4 a[216:219], v55, s[20:23], s71 offen nt
  v_dot2_f32_bf16 v48, v88, v20, 0
  v_dot2_f32_bf16 v48, v89, v21, v48
  v_dot2_f32_bf16 v48, v90, v22, v48
  v_dot2_f32_bf16 v48, v91, v23, v48
  s_waitcnt vmcnt(7)
  buffer_load_dwordx4 v[72:75], v11, s[8:11], s60 offen nt
  v_dot2_f32_bf16 v48, v92, v24, v48
  v_dot2_f32_bf16 v48, v93, v25, v48
  v_dot2_f32_bf16 v48, v94, v26, v48
  v_dot2_f32_bf16 v48, v95, v27, v48
  s_waitcnt vmcnt(7)
  s_lshr_b32 s60, s61, 16
  s_mul_i32 s60, s60, 384
  buffer_load_dwordx4 v[76:79], v10, s[8:11], s60 offen nt
  v_dot2_f32_bf16 v48, v96, v28, v48
  v_dot2_f32_bf16 v48, v97, v29, v48
  v_dot2_f32_bf16 v48, v98, v30, v48
  v_dot2_f32_bf16 v48, v99, v31, v48
  s_nop 2
  v_add_f32_dpp v48, v48, v48 quad_perm:[1,0,3,2] row_mask:0xf bank_mask:0xf
  s_nop 1
  v_add_f32_dpp v48, v48, v48 quad_perm:[2,3,0,1] row_mask:0xf bank_mask:0xf
  s_nop 1
  v_add_f32_dpp v48, v48, v48 row_half_mirror row_mask:0xf bank_mask:0xf
  v_cvt_pk_bf16_f32 v48, v48, v48
  v_and_b32 v48, s72, v48
  v_mul_f32 v48, s66, v48
  v_cvt_pk_bf16_f32 v48, v48, v48
  v_and_b32 v246, s72, v48
  ds_write_b32 v252, v246 offset:120
  v_accvgpr_read_b32 v232, a48
  v_accvgpr_read_b32 v233, a49
  v_accvgpr_read_b32 v234, a50
  v_accvgpr_read_b32 v235, a51
  v_dot2_f32_bf16 v48, v232, v20, 0
  v_dot2_f32_bf16 v48, v233, v21, v48
  v_dot2_f32_bf16 v48, v234, v22, v48
  v_dot2_f32_bf16 v48, v235, v23, v48
  v_accvgpr_read_b32 v236, a52
  v_accvgpr_read_b32 v237, a53
  v_accvgpr_read_b32 v238, a54
  v_accvgpr_read_b32 v239, a55
  v_dot2_f32_bf16 v48, v236, v24, v48
  v_dot2_f32_bf16 v48, v237, v25, v48
  v_dot2_f32_bf16 v48, v238, v26, v48
  v_dot2_f32_bf16 v48, v239, v27, v48
  v_accvgpr_read_b32 v240, a56
  v_accvgpr_read_b32 v241, a57
  v_accvgpr_read_b32 v242, a58
  v_accvgpr_read_b32 v243, a59
  v_dot2_f32_bf16 v48, v240, v28, v48
  v_dot2_f32_bf16 v48, v241, v29, v48
  v_dot2_f32_bf16 v48, v242, v30, v48
  v_dot2_f32_bf16 v48, v243, v31, v48
  s_nop 2
  v_add_f32_dpp v48, v48, v48 quad_perm:[1,0,3,2] row_mask:0xf bank_mask:0xf
  s_nop 1
  v_add_f32_dpp v48, v48, v48 quad_perm:[2,3,0,1] row_mask:0xf bank_mask:0xf
  s_nop 1
  v_add_f32_dpp v48, v48, v48 row_half_mirror row_mask:0xf bank_mask:0xf
  v_cvt_pk_bf16_f32 v48, v48, v48
  v_and_b32 v48, s72, v48
  v_mul_f32 v48, s66, v48
  v_cvt_pk_bf16_f32 v48, v48, v48
  v_and_b32 v49, s72, v48
  ds_write_b32 v252, v49 offset:56
  v_accvgpr_read_b32 v232, a60
  v_accvgpr_read_b32 v233, a61
  v_accvgpr_read_b32 v234, a62
  v_accvgpr_read_b32 v235, a63
  v_dot2_f32_bf16 v48, v232, v20, 0
  v_dot2_f32_bf16 v48, v233, v21, v48
  v_dot2_f32_bf16 v48, v234, v22, v48
  v_dot2_f32_bf16 v48, v235, v23, v48
  v_accvgpr_read_b32 v236, a64
  v_accvgpr_read_b32 v237, a65
  v_accvgpr_read_b32 v238, a66
  v_accvgpr_read_b32 v239, a67
  v_dot2_f32_bf16 v48, v236, v24, v48
  v_dot2_f32_bf16 v48, v237, v25, v48
  v_dot2_f32_bf16 v48, v238, v26, v48
  v_dot2_f32_bf16 v48, v239, v27, v48
  v_accvgpr_read_b32 v240, a68
  v_accvgpr_read_b32 v241, a69
  v_accvgpr_read_b32 v242, a70
  v_accvgpr_read_b32 v243, a71
  v_dot2_f32_bf16 v48, v240, v28, v48
  v_dot2_f32_bf16 v48, v241, v29, v48
  v_dot2_f32_bf16 v48, v242, v30, v48
  v_dot2_f32_bf16 v48, v243, v31, v48
  s_nop 2
  v_add_f32_dpp v48, v48, v48 quad_perm:[1,0,3,2] row_mask:0xf bank_mask:0xf
  s_nop 1
  v_add_f32_dpp v48, v48, v48 quad_perm:[2,3,0,1] row_mask:0xf bank_mask:0xf
  s_nop 1
  v_add_f32_dpp v48, v48, v48 row_half_mirror row_mask:0xf bank_mask:0xf
  v_cvt_pk_bf16_f32 v48, v48, v48
  v_and_b32 v48, s72, v48
  v_mul_f32 v48, s66, v48
  v_cvt_pk_bf16_f32 v48, v48, v48
  v_and_b32 v49, s72, v48
  ds_write_b32 v252, v49 offset:60
  s_waitcnt vmcnt(7)
  v_readlane_b32 s61, v14, 16
  buffer_load_dwordx4 v[80:83], v10, s[8:11], s60 offen offset:128 nt
  v_dot2_f32_bf16 v48, v100, v20, 0
  v_dot2_f32_bf16 v48, v101, v21, v48
  v_dot2_f32_bf16 v48, v102, v22, v48
  v_dot2_f32_bf16 v48, v103, v23, v48
  s_waitcnt vmcnt(7)
  buffer_load_dwordx4 a[220:223], v55, s[20:23], s71 offen offset:256 nt
  v_dot2_f32_bf16 v48, v104, v24, v48
  v_dot2_f32_bf16 v48, v105, v25, v48
  v_dot2_f32_bf16 v48, v106, v26, v48
  v_dot2_f32_bf16 v48, v107, v27, v48
  s_waitcnt vmcnt(7)
  buffer_load_dwordx4 v[84:87], v11, s[8:11], s60 offen nt
  v_dot2_f32_bf16 v48, v108, v28, v48
  v_dot2_f32_bf16 v48, v109, v29, v48
  v_dot2_f32_bf16 v48, v110, v30, v48
  v_dot2_f32_bf16 v48, v111, v31, v48
  s_nop 2
  v_add_f32_dpp v48, v48, v48 quad_perm:[1,0,3,2] row_mask:0xf bank_mask:0xf
  s_nop 1
  v_add_f32_dpp v48, v48, v48 quad_perm:[2,3,0,1] row_mask:0xf bank_mask:0xf
  s_nop 1
  v_add_f32_dpp v48, v48, v48 row_half_mirror row_mask:0xf bank_mask:0xf
  v_cvt_pk_bf16_f32 v48, v48, v48
  v_and_b32 v48, s72, v48
  v_mul_f32 v48, s66, v48
  v_cvt_pk_bf16_f32 v48, v48, v48
  v_and_b32 v247, s72, v48
  ds_write_b32 v252, v247 offset:124
  v_accvgpr_read_b32 v232, a72
  v_accvgpr_read_b32 v233, a73
  v_accvgpr_read_b32 v234, a74
  v_accvgpr_read_b32 v235, a75
  v_dot2_f32_bf16 v48, v232, v20, 0
  v_dot2_f32_bf16 v48, v233, v21, v48
  v_dot2_f32_bf16 v48, v234, v22, v48
  v_dot2_f32_bf16 v48, v235, v23, v48
  v_accvgpr_read_b32 v236, a76
  v_accvgpr_read_b32 v237, a77
  v_accvgpr_read_b32 v238, a78
  v_accvgpr_read_b32 v239, a79
  v_dot2_f32_bf16 v48, v236, v24, v48
  v_dot2_f32_bf16 v48, v237, v25, v48
  v_dot2_f32_bf16 v48, v238, v26, v48
  v_dot2_f32_bf16 v48, v239, v27, v48
  v_accvgpr_read_b32 v240, a80
  v_accvgpr_read_b32 v241, a81
  v_accvgpr_read_b32 v242, a82
  v_accvgpr_read_b32 v243, a83
  v_dot2_f32_bf16 v48, v240, v28, v48
  v_dot2_f32_bf16 v48, v241, v29, v48
  v_dot2_f32_bf16 v48, v242, v30, v48
  v_dot2_f32_bf16 v48, v243, v31, v48
  s_nop 2
  v_add_f32_dpp v48, v48, v48 quad_perm:[1,0,3,2] row_mask:0xf bank_mask:0xf
  s_nop 1
  v_add_f32_dpp v48, v48, v48 quad_perm:[2,3,0,1] row_mask:0xf bank_mask:0xf
  s_nop 1
  v_add_f32_dpp v48, v48, v48 row_half_mirror row_mask:0xf bank_mask:0xf
  v_cvt_pk_bf16_f32 v48, v48, v48
  v_and_b32 v48, s72, v48
  v_mul_f32 v48, s66, v48
  v_cvt_pk_bf16_f32 v48, v48, v48
  v_and_b32 v49, s72, v48
  ds_write_b32 v252, v49 offset:64
  v_accvgpr_read_b32 v232, a84
  v_accvgpr_read_b32 v233, a85
  v_accvgpr_read_b32 v234, a86
  v_accvgpr_read_b32 v235, a87
  v_dot2_f32_bf16 v48, v232, v20, 0
  v_dot2_f32_bf16 v48, v233, v21, v48
  v_dot2_f32_bf16 v48, v234, v22, v48
  v_dot2_f32_bf16 v48, v235, v23, v48
  v_accvgpr_read_b32 v236, a88
  v_accvgpr_read_b32 v237, a89
  v_accvgpr_read_b32 v238, a90
  v_accvgpr_read_b32 v239, a91
  v_dot2_f32_bf16 v48, v236, v24, v48
  v_dot2_f32_bf16 v48, v237, v25, v48
  v_dot2_f32_bf16 v48, v238, v26, v48
  v_dot2_f32_bf16 v48, v239, v27, v48
  v_accvgpr_read_b32 v240, a92
  v_accvgpr_read_b32 v241, a93
  v_accvgpr_read_b32 v242, a94
  v_accvgpr_read_b32 v243, a95
  v_dot2_f32_bf16 v48, v240, v28, v48
  v_dot2_f32_bf16 v48, v241, v29, v48
  v_dot2_f32_bf16 v48, v242, v30, v48
  v_dot2_f32_bf16 v48, v243, v31, v48
  s_nop 2
  v_add_f32_dpp v48, v48, v48 quad_perm:[1,0,3,2] row_mask:0xf bank_mask:0xf
  s_nop 1
  v_add_f32_dpp v48, v48, v48 quad_perm:[2,3,0,1] row_mask:0xf bank_mask:0xf
  s_nop 1
  v_add_f32_dpp v48, v48, v48 row_half_mirror row_mask:0xf bank_mask:0xf
  v_cvt_pk_bf16_f32 v48, v48, v48
  v_and_b32 v48, s72, v48
  v_mul_f32 v48, s66, v48
  v_cvt_pk_bf16_f32 v48, v48, v48
  v_and_b32 v49, s72, v48
  ds_write_b32 v252, v49 offset:68
  s_waitcnt vmcnt(7)
  s_and_b32 s60, s61, 0xffff
  s_mul_i32 s60, s60, 384
  buffer_load_dwordx4 v[88:91], v10, s[8:11], s60 offen nt
  v_dot2_f32_bf16 v48, v64, v20, 0
  v_dot2_f32_bf16 v48, v65, v21, v48
  v_dot2_f32_bf16 v48, v66, v22, v48
  v_dot2_f32_bf16 v48, v67, v23, v48
  s_waitcnt vmcnt(7)
  buffer_load_dwordx4 v[92:95], v10, s[8:11], s60 offen offset:128 nt
  v_dot2_f32_bf16 v48, v68, v24, v48
  v_dot2_f32_bf16 v48, v69, v25, v48
  v_dot2_f32_bf16 v48, v70, v26, v48
  v_dot2_f32_bf16 v48, v71, v27, v48
  s_waitcnt vmcnt(7)
  buffer_load_dwordx4 a[224:227], v55, s[20:23], s71 offen offset:512 nt
  s_waitcnt vmcnt(7)
  buffer_load_dwordx4 v[96:99], v11, s[8:11], s60 offen nt
  v_dot2_f32_bf16 v48, v72, v28, v48
  v_dot2_f32_bf16 v48, v73, v29, v48
  v_dot2_f32_bf16 v48, v74, v30, v48
  v_dot2_f32_bf16 v48, v75, v31, v48
  s_nop 2
  v_add_f32_dpp v48, v48, v48 quad_perm:[1,0,3,2] row_mask:0xf bank_mask:0xf
  s_nop 1
  v_add_f32_dpp v48, v48, v48 quad_perm:[2,3,0,1] row_mask:0xf bank_mask:0xf
  s_nop 1
  v_add_f32_dpp v48, v48, v48 row_half_mirror row_mask:0xf bank_mask:0xf
  v_cvt_pk_bf16_f32 v48, v48, v48
  v_and_b32 v48, s72, v48
  v_mul_f32 v48, s66, v48
  v_cvt_pk_bf16_f32 v48, v48, v48
  v_and_b32 v244, s72, v48
  ds_write_b32 v252, v244 offset:128
  v_accvgpr_read_b32 v232, a96
  v_accvgpr_read_b32 v233, a97
  v_accvgpr_read_b32 v234, a98
  v_accvgpr_read_b32 v235, a99
  v_dot2_f32_bf16 v48, v232, v20, 0
  v_dot2_f32_bf16 v48, v233, v21, v48
  v_dot2_f32_bf16 v48, v234, v22, v48
  v_dot2_f32_bf16 v48, v235, v23, v48
  v_accvgpr_read_b32 v236, a100
  v_accvgpr_read_b32 v237, a101
  v_accvgpr_read_b32 v238, a102
  v_accvgpr_read_b32 v239, a103
  v_dot2_f32_bf16 v48, v236, v24, v48
  v_dot2_f32_bf16 v48, v237, v25, v48
  v_dot2_f32_bf16 v48, v238, v26, v48
  v_dot2_f32_bf16 v48, v239, v27, v48
  v_accvgpr_read_b32 v240, a104
  v_accvgpr_read_b32 v241, a105
  v_accvgpr_read_b32 v242, a106
  v_accvgpr_read_b32 v243, a107
  v_dot2_f32_bf16 v48, v240, v28, v48
  v_dot2_f32_bf16 v48, v241, v29, v48
  v_dot2_f32_bf16 v48, v242, v30, v48
  v_dot2_f32_bf16 v48, v243, v31, v48
  s_nop 2
  v_add_f32_dpp v48, v48, v48 quad_perm:[1,0,3,2] row_mask:0xf bank_mask:0xf
  s_nop 1
  v_add_f32_dpp v48, v48, v48 quad_perm:[2,3,0,1] row_mask:0xf bank_mask:0xf
  s_nop 1
  v_add_f32_dpp v48, v48, v48 row_half_mirror row_mask:0xf bank_mask:0xf
  v_cvt_pk_bf16_f32 v48, v48, v48
  v_and_b32 v48, s72, v48
  v_mul_f32 v48, s66, v48
  v_cvt_pk_bf16_f32 v48, v48, v48
  v_and_b32 v49, s72, v48
  ds_write_b32 v252, v49 offset:72
  v_accvgpr_read_b32 v232, a108
  v_accvgpr_read_b32 v233, a109
  v_accvgpr_read_b32 v234, a110
  v_accvgpr_read_b32 v235, a111
  v_dot2_f32_bf16 v48, v232, v20, 0
  v_dot2_f32_bf16 v48, v233, v21, v48
  v_dot2_f32_bf16 v48, v234, v22, v48
  v_dot2_f32_bf16 v48, v235, v23, v48
  v_accvgpr_read_b32 v236, a112
  v_accvgpr_read_b32 v237, a113
  v_accvgpr_read_b32 v238, a114
  v_accvgpr_read_b32 v239, a115
  v_dot2_f32_bf16 v48, v236, v24, v48
  v_dot2_f32_bf16 v48, v237, v25, v48
  v_dot2_f32_bf16 v48, v238, v26, v48
  v_dot2_f32_bf16 v48, v239, v27, v48
  v_accvgpr_read_b32 v240, a116
  v_accvgpr_read_b32 v241, a117
  v_accvgpr_read_b32 v242, a118
  v_accvgpr_read_b32 v243, a119
  v_dot2_f32_bf16 v48, v240, v28, v48
  v_dot2_f32_bf16 v48, v241, v29, v48
  v_dot2_f32_bf16 v48, v242, v30, v48
  v_dot2_f32_bf16 v48, v243, v31, v48
  s_nop 2
  v_add_f32_dpp v48, v48, v48 quad_perm:[1,0,3,2] row_mask:0xf bank_mask:0xf
  s_nop 1
  v_add_f32_dpp v48, v48, v48 quad_perm:[2,3,0,1] row_mask:0xf bank_mask:0xf
  s_nop 1
  v_add_f32_dpp v48, v48, v48 row_half_mirror row_mask:0xf bank_mask:0xf
  v_cvt_pk_bf16_f32 v48, v48, v48
  v_and_b32 v48, s72, v48
  v_mul_f32 v48, s66, v48
  v_cvt_pk_bf16_f32 v48, v48, v48
  v_and_b32 v49, s72, v48
  ds_write_b32 v252, v49 offset:76
  s_waitcnt vmcnt(7)
  s_lshr_b32 s60, s61, 16
  s_mul_i32 s60, s60, 384
  buffer_load_dwordx4 v[100:103], v10, s[8:11], s60 offen nt
  v_dot2_f32_bf16 v48, v76, v20, 0
  v_dot2_f32_bf16 v48, v77, v21, v48
  v_dot2_f32_bf16 v48, v78, v22, v48
  v_dot2_f32_bf16 v48, v79, v23, v48
  s_waitcnt vmcnt(7)
  v_readlane_b32 s61, v14, 17
  buffer_load_dwordx4 v[104:107], v10, s[8:11], s60 offen offset:128 nt
  v_dot2_f32_bf16 v48, v80, v24, v48
  v_dot2_f32_bf16 v48, v81, v25, v48
  v_dot2_f32_bf16 v48, v82, v26, v48
  v_dot2_f32_bf16 v48, v83, v27, v48
  s_waitcnt vmcnt(7)
  buffer_load_dwordx4 a[228:231], v55, s[20:23], s71 offen offset:768 nt
  s_waitcnt vmcnt(7)
  buffer_load_dwordx4 v[108:111], v11, s[8:11], s60 offen nt
  v_dot2_f32_bf16 v48, v84, v28, v48
  v_dot2_f32_bf16 v48, v85, v29, v48
  v_dot2_f32_bf16 v48, v86, v30, v48
  v_dot2_f32_bf16 v48, v87, v31, v48
  s_nop 2
  v_add_f32_dpp v48, v48, v48 quad_perm:[1,0,3,2] row_mask:0xf bank_mask:0xf
  s_nop 1
  v_add_f32_dpp v48, v48, v48 quad_perm:[2,3,0,1] row_mask:0xf bank_mask:0xf
  s_nop 1
  v_add_f32_dpp v48, v48, v48 row_half_mirror row_mask:0xf bank_mask:0xf
  v_cvt_pk_bf16_f32 v48, v48, v48
  v_and_b32 v48, s72, v48
  v_mul_f32 v48, s66, v48
  v_cvt_pk_bf16_f32 v48, v48, v48
  v_and_b32 v245, s72, v48
  ds_write_b32 v252, v245 offset:132
  v_accvgpr_read_b32 v232, a120
  v_accvgpr_read_b32 v233, a121
  v_accvgpr_read_b32 v234, a122
  v_accvgpr_read_b32 v235, a123
  v_dot2_f32_bf16 v48, v232, v20, 0
  v_dot2_f32_bf16 v48, v233, v21, v48
  v_dot2_f32_bf16 v48, v234, v22, v48
  v_dot2_f32_bf16 v48, v235, v23, v48
  v_accvgpr_read_b32 v236, a124
  v_accvgpr_read_b32 v237, a125
  v_accvgpr_read_b32 v238, a126
  v_accvgpr_read_b32 v239, a127
  v_dot2_f32_bf16 v48, v236, v24, v48
  v_dot2_f32_bf16 v48, v237, v25, v48
  v_dot2_f32_bf16 v48, v238, v26, v48
  v_dot2_f32_bf16 v48, v239, v27, v48
  v_accvgpr_read_b32 v240, a128
  v_accvgpr_read_b32 v241, a129
  v_accvgpr_read_b32 v242, a130
  v_accvgpr_read_b32 v243, a131
  v_dot2_f32_bf16 v48, v240, v28, v48
  v_dot2_f32_bf16 v48, v241, v29, v48
  v_dot2_f32_bf16 v48, v242, v30, v48
  v_dot2_f32_bf16 v48, v243, v31, v48
  s_nop 2
  v_add_f32_dpp v48, v48, v48 quad_perm:[1,0,3,2] row_mask:0xf bank_mask:0xf
  s_nop 1
  v_add_f32_dpp v48, v48, v48 quad_perm:[2,3,0,1] row_mask:0xf bank_mask:0xf
  s_nop 1
  v_add_f32_dpp v48, v48, v48 row_half_mirror row_mask:0xf bank_mask:0xf
  v_cvt_pk_bf16_f32 v48, v48, v48
  v_and_b32 v48, s72, v48
  v_mul_f32 v48, s66, v48
  v_cvt_pk_bf16_f32 v48, v48, v48
  v_and_b32 v49, s72, v48
  ds_write_b32 v252, v49 offset:80
  v_accvgpr_read_b32 v232, a132
  v_accvgpr_read_b32 v233, a133
  v_accvgpr_read_b32 v234, a134
  v_accvgpr_read_b32 v235, a135
  v_dot2_f32_bf16 v48, v232, v20, 0
  v_dot2_f32_bf16 v48, v233, v21, v48
  v_dot2_f32_bf16 v48, v234, v22, v48
  v_dot2_f32_bf16 v48, v235, v23, v48
  v_accvgpr_read_b32 v236, a136
  v_accvgpr_read_b32 v237, a137
  v_accvgpr_read_b32 v238, a138
  v_accvgpr_read_b32 v239, a139
  v_dot2_f32_bf16 v48, v236, v24, v48
  v_dot2_f32_bf16 v48, v237, v25, v48
  v_dot2_f32_bf16 v48, v238, v26, v48
  v_dot2_f32_bf16 v48, v239, v27, v48
  v_accvgpr_read_b32 v240, a140
  v_accvgpr_read_b32 v241, a141
  v_accvgpr_read_b32 v242, a142
  v_accvgpr_read_b32 v243, a143
  v_dot2_f32_bf16 v48, v240, v28, v48
  v_dot2_f32_bf16 v48, v241, v29, v48
  v_dot2_f32_bf16 v48, v242, v30, v48
  v_dot2_f32_bf16 v48, v243, v31, v48
  s_nop 2
  v_add_f32_dpp v48, v48, v48 quad_perm:[1,0,3,2] row_mask:0xf bank_mask:0xf
  s_nop 1
  v_add_f32_dpp v48, v48, v48 quad_perm:[2,3,0,1] row_mask:0xf bank_mask:0xf
  s_nop 1
  v_add_f32_dpp v48, v48, v48 row_half_mirror row_mask:0xf bank_mask:0xf
  v_cvt_pk_bf16_f32 v48, v48, v48
  v_and_b32 v48, s72, v48
  v_mul_f32 v48, s66, v48
  v_cvt_pk_bf16_f32 v48, v48, v48
  v_and_b32 v49, s72, v48
  ds_write_b32 v252, v49 offset:84
  s_waitcnt vmcnt(7)
  s_and_b32 s60, s61, 0xffff
  s_mul_i32 s60, s60, 384
  buffer_load_dwordx4 v[64:67], v10, s[8:11], s60 offen nt
  v_dot2_f32_bf16 v48, v88, v20, 0
  v_dot2_f32_bf16 v48, v89, v21, v48
  v_dot2_f32_bf16 v48, v90, v22, v48
  v_dot2_f32_bf16 v48, v91, v23, v48
  s_waitcnt vmcnt(7)
  buffer_load_dwordx4 v[68:71], v10, s[8:11], s60 offen offset:128 nt
  v_dot2_f32_bf16 v48, v92, v24, v48
  v_dot2_f32_bf16 v48, v93, v25, v48
  v_dot2_f32_bf16 v48, v94, v26, v48
  v_dot2_f32_bf16 v48, v95, v27, v48
  s_waitcnt vmcnt(7)
  buffer_load_dwordx4 a[232:235], v55, s[20:23], s71 offen offset:1024 nt
  s_waitcnt vmcnt(7)
  buffer_load_dwordx4 v[72:75], v11, s[8:11], s60 offen nt
  v_dot2_f32_bf16 v48, v96, v28, v48
  v_dot2_f32_bf16 v48, v97, v29, v48
  v_dot2_f32_bf16 v48, v98, v30, v48
  v_dot2_f32_bf16 v48, v99, v31, v48
  s_nop 2
  v_add_f32_dpp v48, v48, v48 quad_perm:[1,0,3,2] row_mask:0xf bank_mask:0xf
  s_nop 1
  v_add_f32_dpp v48, v48, v48 quad_perm:[2,3,0,1] row_mask:0xf bank_mask:0xf
  s_nop 1
  v_add_f32_dpp v48, v48, v48 row_half_mirror row_mask:0xf bank_mask:0xf
  v_cvt_pk_bf16_f32 v48, v48, v48
  v_and_b32 v48, s72, v48
  v_mul_f32 v48, s66, v48
  v_cvt_pk_bf16_f32 v48, v48, v48
  v_and_b32 v246, s72, v48
  ds_write_b32 v252, v246 offset:136
  v_accvgpr_read_b32 v232, a144
  v_accvgpr_read_b32 v233, a145
  v_accvgpr_read_b32 v234, a146
  v_accvgpr_read_b32 v235, a147
  v_dot2_f32_bf16 v48, v232, v20, 0
  v_dot2_f32_bf16 v48, v233, v21, v48
  v_dot2_f32_bf16 v48, v234, v22, v48
  v_dot2_f32_bf16 v48, v235, v23, v48
  v_accvgpr_read_b32 v236, a148
  v_accvgpr_read_b32 v237, a149
  v_accvgpr_read_b32 v238, a150
  v_accvgpr_read_b32 v239, a151
  v_dot2_f32_bf16 v48, v236, v24, v48
  v_dot2_f32_bf16 v48, v237, v25, v48
  v_dot2_f32_bf16 v48, v238, v26, v48
  v_dot2_f32_bf16 v48, v239, v27, v48
  v_accvgpr_read_b32 v240, a152
  v_accvgpr_read_b32 v241, a153
  v_accvgpr_read_b32 v242, a154
  v_accvgpr_read_b32 v243, a155
  v_dot2_f32_bf16 v48, v240, v28, v48
  v_dot2_f32_bf16 v48, v241, v29, v48
  v_dot2_f32_bf16 v48, v242, v30, v48
  v_dot2_f32_bf16 v48, v243, v31, v48
  s_nop 2
  v_add_f32_dpp v48, v48, v48 quad_perm:[1,0,3,2] row_mask:0xf bank_mask:0xf
  s_nop 1
  v_add_f32_dpp v48, v48, v48 quad_perm:[2,3,0,1] row_mask:0xf bank_mask:0xf
  s_nop 1
  v_add_f32_dpp v48, v48, v48 row_half_mirror row_mask:0xf bank_mask:0xf
  v_cvt_pk_bf16_f32 v48, v48, v48
  v_and_b32 v48, s72, v48
  v_mul_f32 v48, s66, v48
  v_cvt_pk_bf16_f32 v48, v48, v48
  v_and_b32 v49, s72, v48
  ds_write_b32 v252, v49 offset:88
  v_accvgpr_read_b32 v232, a156
  v_accvgpr_read_b32 v233, a157
  v_accvgpr_read_b32 v234, a158
  v_accvgpr_read_b32 v235, a159
  v_dot2_f32_bf16 v48, v232, v20, 0
  v_dot2_f32_bf16 v48, v233, v21, v48
  v_dot2_f32_bf16 v48, v234, v22, v48
  v_dot2_f32_bf16 v48, v235, v23, v48
  v_accvgpr_read_b32 v236, a160
  v_accvgpr_read_b32 v237, a161
  v_accvgpr_read_b32 v238, a162
  v_accvgpr_read_b32 v239, a163
  v_dot2_f32_bf16 v48, v236, v24, v48
  v_dot2_f32_bf16 v48, v237, v25, v48
  v_dot2_f32_bf16 v48, v238, v26, v48
  v_dot2_f32_bf16 v48, v239, v27, v48
  v_accvgpr_read_b32 v240, a164
  v_accvgpr_read_b32 v241, a165
  v_accvgpr_read_b32 v242, a166
  v_accvgpr_read_b32 v243, a167
  v_dot2_f32_bf16 v48, v240, v28, v48
  v_dot2_f32_bf16 v48, v241, v29, v48
  v_dot2_f32_bf16 v48, v242, v30, v48
  v_dot2_f32_bf16 v48, v243, v31, v48
  s_nop 2
  v_add_f32_dpp v48, v48, v48 quad_perm:[1,0,3,2] row_mask:0xf bank_mask:0xf
  s_nop 1
  v_add_f32_dpp v48, v48, v48 quad_perm:[2,3,0,1] row_mask:0xf bank_mask:0xf
  s_nop 1
  v_add_f32_dpp v48, v48, v48 row_half_mirror row_mask:0xf bank_mask:0xf
  v_cvt_pk_bf16_f32 v48, v48, v48
  v_and_b32 v48, s72, v48
  v_mul_f32 v48, s66, v48
  v_cvt_pk_bf16_f32 v48, v48, v48
  v_and_b32 v49, s72, v48
  ds_write_b32 v252, v49 offset:92
  s_waitcnt vmcnt(7)
  s_lshr_b32 s60, s61, 16
  s_mul_i32 s60, s60, 384
  buffer_load_dwordx4 v[76:79], v10, s[8:11], s60 offen nt
  v_dot2_f32_bf16 v48, v100, v20, 0
  v_dot2_f32_bf16 v48, v101, v21, v48
  v_dot2_f32_bf16 v48, v102, v22, v48
  v_dot2_f32_bf16 v48, v103, v23, v48
  s_waitcnt vmcnt(7)
  v_readlane_b32 s61, v14, 18
  buffer_load_dwordx4 v[80:83], v10, s[8:11], s60 offen offset:128 nt
  v_dot2_f32_bf16 v48, v104, v24, v48
  v_dot2_f32_bf16 v48, v105, v25, v48
  v_dot2_f32_bf16 v48, v106, v26, v48
  v_dot2_f32_bf16 v48, v107, v27, v48
  s_waitcnt vmcnt(7)
  buffer_load_dwordx4 a[236:239], v55, s[20:23], s71 offen offset:1280 nt
  s_waitcnt vmcnt(7)
  buffer_load_dwordx4 v[84:87], v11, s[8:11], s60 offen nt
  v_dot2_f32_bf16 v48, v108, v28, v48
  v_dot2_f32_bf16 v48, v109, v29, v48
  v_dot2_f32_bf16 v48, v110, v30, v48
  v_dot2_f32_bf16 v48, v111, v31, v48
  s_nop 2
  v_add_f32_dpp v48, v48, v48 quad_perm:[1,0,3,2] row_mask:0xf bank_mask:0xf
  s_nop 1
  v_add_f32_dpp v48, v48, v48 quad_perm:[2,3,0,1] row_mask:0xf bank_mask:0xf
  s_nop 1
  v_add_f32_dpp v48, v48, v48 row_half_mirror row_mask:0xf bank_mask:0xf
  v_cvt_pk_bf16_f32 v48, v48, v48
  v_and_b32 v48, s72, v48
  v_mul_f32 v48, s66, v48
  v_cvt_pk_bf16_f32 v48, v48, v48
  v_and_b32 v247, s72, v48
  ds_write_b32 v252, v247 offset:140
  v_accvgpr_read_b32 v232, a168
  v_accvgpr_read_b32 v233, a169
  v_accvgpr_read_b32 v234, a170
  v_accvgpr_read_b32 v235, a171
  v_dot2_f32_bf16 v48, v232, v20, 0
  v_dot2_f32_bf16 v48, v233, v21, v48
  v_dot2_f32_bf16 v48, v234, v22, v48
  v_dot2_f32_bf16 v48, v235, v23, v48
  v_accvgpr_read_b32 v236, a172
  v_accvgpr_read_b32 v237, a173
  v_accvgpr_read_b32 v238, a174
  v_accvgpr_read_b32 v239, a175
  v_dot2_f32_bf16 v48, v236, v24, v48
  v_dot2_f32_bf16 v48, v237, v25, v48
  v_dot2_f32_bf16 v48, v238, v26, v48
  v_dot2_f32_bf16 v48, v239, v27, v48
  v_accvgpr_read_b32 v240, a176
  v_accvgpr_read_b32 v241, a177
  v_accvgpr_read_b32 v242, a178
  v_accvgpr_read_b32 v243, a179
  v_dot2_f32_bf16 v48, v240, v28, v48
  v_dot2_f32_bf16 v48, v241, v29, v48
  v_dot2_f32_bf16 v48, v242, v30, v48
  v_dot2_f32_bf16 v48, v243, v31, v48
  s_nop 2
  v_add_f32_dpp v48, v48, v48 quad_perm:[1,0,3,2] row_mask:0xf bank_mask:0xf
  s_nop 1
  v_add_f32_dpp v48, v48, v48 quad_perm:[2,3,0,1] row_mask:0xf bank_mask:0xf
  s_nop 1
  v_add_f32_dpp v48, v48, v48 row_half_mirror row_mask:0xf bank_mask:0xf
  v_cvt_pk_bf16_f32 v48, v48, v48
  v_and_b32 v48, s72, v48
  v_mul_f32 v48, s66, v48
  v_cvt_pk_bf16_f32 v48, v48, v48
  v_and_b32 v49, s72, v48
  ds_write_b32 v252, v49 offset:96
  v_accvgpr_read_b32 v232, a180
  v_accvgpr_read_b32 v233, a181
  v_accvgpr_read_b32 v234, a182
  v_accvgpr_read_b32 v235, a183
  v_dot2_f32_bf16 v48, v232, v20, 0
  v_dot2_f32_bf16 v48, v233, v21, v48
  v_dot2_f32_bf16 v48, v234, v22, v48
  v_dot2_f32_bf16 v48, v235, v23, v48
  v_accvgpr_read_b32 v236, a184
  v_accvgpr_read_b32 v237, a185
  v_accvgpr_read_b32 v238, a186
  v_accvgpr_read_b32 v239, a187
  v_dot2_f32_bf16 v48, v236, v24, v48
  v_dot2_f32_bf16 v48, v237, v25, v48
  v_dot2_f32_bf16 v48, v238, v26, v48
  v_dot2_f32_bf16 v48, v239, v27, v48
  v_accvgpr_read_b32 v240, a188
  v_accvgpr_read_b32 v241, a189
  v_accvgpr_read_b32 v242, a190
  v_accvgpr_read_b32 v243, a191
  v_dot2_f32_bf16 v48, v240, v28, v48
  v_dot2_f32_bf16 v48, v241, v29, v48
  v_dot2_f32_bf16 v48, v242, v30, v48
  v_dot2_f32_bf16 v48, v243, v31, v48
  s_nop 2
  v_add_f32_dpp v48, v48, v48 quad_perm:[1,0,3,2] row_mask:0xf bank_mask:0xf
  s_nop 1
  v_add_f32_dpp v48, v48, v48 quad_perm:[2,3,0,1] row_mask:0xf bank_mask:0xf
  s_nop 1
  v_add_f32_dpp v48, v48, v48 row_half_mirror row_mask:0xf bank_mask:0xf
  v_cvt_pk_bf16_f32 v48, v48, v48
  v_and_b32 v48, s72, v48
  v_mul_f32 v48, s66, v48
  v_cvt_pk_bf16_f32 v48, v48, v48
  v_and_b32 v49, s72, v48
  ds_write_b32 v252, v49 offset:100
  s_waitcnt vmcnt(7)
  s_and_b32 s60, s61, 0xffff
  s_mul_i32 s60, s60, 384
  buffer_load_dwordx4 v[88:91], v10, s[8:11], s60 offen nt
  v_dot2_f32_bf16 v48, v64, v20, 0
  v_dot2_f32_bf16 v48, v65, v21, v48
  v_dot2_f32_bf16 v48, v66, v22, v48
  v_dot2_f32_bf16 v48, v67, v23, v48
  s_waitcnt vmcnt(7)
  buffer_load_dwordx4 v[92:95], v10, s[8:11], s60 offen offset:128 nt
  v_dot2_f32_bf16 v48, v68, v24, v48
  v_dot2_f32_bf16 v48, v69, v25, v48
  v_dot2_f32_bf16 v48, v70, v26, v48
  v_dot2_f32_bf16 v48, v71, v27, v48
  s_waitcnt vmcnt(7)
  buffer_load_dwordx4 a[0:3], v55, s[20:23], s71 offen offset:1536 nt
  s_waitcnt vmcnt(7)
  buffer_load_dwordx4 v[96:99], v11, s[8:11], s60 offen nt
  v_dot2_f32_bf16 v48, v72, v28, v48
  v_dot2_f32_bf16 v48, v73, v29, v48
  v_dot2_f32_bf16 v48, v74, v30, v48
  v_dot2_f32_bf16 v48, v75, v31, v48
  s_nop 2
  v_add_f32_dpp v48, v48, v48 quad_perm:[1,0,3,2] row_mask:0xf bank_mask:0xf
  s_nop 1
  v_add_f32_dpp v48, v48, v48 quad_perm:[2,3,0,1] row_mask:0xf bank_mask:0xf
  s_nop 1
  v_add_f32_dpp v48, v48, v48 row_half_mirror row_mask:0xf bank_mask:0xf
  v_cvt_pk_bf16_f32 v48, v48, v48
  v_and_b32 v48, s72, v48
  v_mul_f32 v48, s66, v48
  v_cvt_pk_bf16_f32 v48, v48, v48
  v_and_b32 v244, s72, v48
  ds_write_b32 v252, v244 offset:144
  v_accvgpr_read_b32 v232, a192
  v_accvgpr_read_b32 v233, a193
  v_accvgpr_read_b32 v234, a194
  v_accvgpr_read_b32 v235, a195
  v_dot2_f32_bf16 v48, v232, v20, 0
  v_dot2_f32_bf16 v48, v233, v21, v48
  v_dot2_f32_bf16 v48, v234, v22, v48
  v_dot2_f32_bf16 v48, v235, v23, v48
  v_accvgpr_read_b32 v236, a196
  v_accvgpr_read_b32 v237, a197
  v_accvgpr_read_b32 v238, a198
  v_accvgpr_read_b32 v239, a199
  v_dot2_f32_bf16 v48, v236, v24, v48
  v_dot2_f32_bf16 v48, v237, v25, v48
  v_dot2_f32_bf16 v48, v238, v26, v48
  v_dot2_f32_bf16 v48, v239, v27, v48
  v_accvgpr_read_b32 v240, a200
  v_accvgpr_read_b32 v241, a201
  v_accvgpr_read_b32 v242, a202
  v_accvgpr_read_b32 v243, a203
  v_dot2_f32_bf16 v48, v240, v28, v48
  v_dot2_f32_bf16 v48, v241, v29, v48
  v_dot2_f32_bf16 v48, v242, v30, v48
  v_dot2_f32_bf16 v48, v243, v31, v48
  s_nop 2
  v_add_f32_dpp v48, v48, v48 quad_perm:[1,0,3,2] row_mask:0xf bank_mask:0xf
  s_nop 1
  v_add_f32_dpp v48, v48, v48 quad_perm:[2,3,0,1] row_mask:0xf bank_mask:0xf
  s_nop 1
  v_add_f32_dpp v48, v48, v48 row_half_mirror row_mask:0xf bank_mask:0xf
  v_cvt_pk_bf16_f32 v48, v48, v48
  v_and_b32 v48, s72, v48
  v_mul_f32 v48, s66, v48
  v_cvt_pk_bf16_f32 v48, v48, v48
  v_and_b32 v49, s72, v48
  ds_write_b32 v252, v49 offset:104
  v_accvgpr_read_b32 v232, a204
  v_accvgpr_read_b32 v233, a205
  v_accvgpr_read_b32 v234, a206
  v_accvgpr_read_b32 v235, a207
  v_dot2_f32_bf16 v48, v232, v20, 0
  v_dot2_f32_bf16 v48, v233, v21, v48
  v_dot2_f32_bf16 v48, v234, v22, v48
  v_dot2_f32_bf16 v48, v235, v23, v48
  v_accvgpr_read_b32 v236, a208
  v_accvgpr_read_b32 v237, a209
  v_accvgpr_read_b32 v238, a210
  v_accvgpr_read_b32 v239, a211
  v_dot2_f32_bf16 v48, v236, v24, v48
  v_dot2_f32_bf16 v48, v237, v25, v48
  v_dot2_f32_bf16 v48, v238, v26, v48
  v_dot2_f32_bf16 v48, v239, v27, v48
  v_accvgpr_read_b32 v240, a212
  v_accvgpr_read_b32 v241, a213
  v_accvgpr_read_b32 v242, a214
  v_accvgpr_read_b32 v243, a215
  v_dot2_f32_bf16 v48, v240, v28, v48
  v_dot2_f32_bf16 v48, v241, v29, v48
  v_dot2_f32_bf16 v48, v242, v30, v48
  v_dot2_f32_bf16 v48, v243, v31, v48
  s_nop 2
  v_add_f32_dpp v48, v48, v48 quad_perm:[1,0,3,2] row_mask:0xf bank_mask:0xf
  s_nop 1
  v_add_f32_dpp v48, v48, v48 quad_perm:[2,3,0,1] row_mask:0xf bank_mask:0xf
  s_nop 1
  v_add_f32_dpp v48, v48, v48 row_half_mirror row_mask:0xf bank_mask:0xf
  v_cvt_pk_bf16_f32 v48, v48, v48
  v_and_b32 v48, s72, v48
  v_mul_f32 v48, s66, v48
  v_cvt_pk_bf16_f32 v48, v48, v48
  v_and_b32 v49, s72, v48
  ds_write_b32 v252, v49 offset:108
  s_waitcnt vmcnt(7)
  s_lshr_b32 s60, s61, 16
  s_mul_i32 s60, s60, 384
  buffer_load_dwordx4 v[100:103], v10, s[8:11], s60 offen nt
  v_dot2_f32_bf16 v48, v76, v20, 0
  v_dot2_f32_bf16 v48, v77, v21, v48
  v_dot2_f32_bf16 v48, v78, v22, v48
  v_dot2_f32_bf16 v48, v79, v23, v48
  s_waitcnt vmcnt(7)
  v_readlane_b32 s61, v14, 19
  buffer_load_dwordx4 v[104:107], v10, s[8:11], s60 offen offset:128 nt
  v_dot2_f32_bf16 v48, v80, v24, v48
  v_dot2_f32_bf16 v48, v81, v25, v48
  v_dot2_f32_bf16 v48, v82, v26, v48
  v_dot2_f32_bf16 v48, v83, v27, v48
  s_waitcnt vmcnt(7)
  buffer_load_dwordx4 a[4:7], v55, s[20:23], s71 offen offset:1792 nt
  s_waitcnt vmcnt(7)
  buffer_load_dwordx4 v[108:111], v11, s[8:11], s60 offen nt
  v_dot2_f32_bf16 v48, v84, v28, v48
  v_dot2_f32_bf16 v48, v85, v29, v48
  v_dot2_f32_bf16 v48, v86, v30, v48
  v_dot2_f32_bf16 v48, v87, v31, v48
  s_nop 2
  v_add_f32_dpp v48, v48, v48 quad_perm:[1,0,3,2] row_mask:0xf bank_mask:0xf
  s_nop 1
  v_add_f32_dpp v48, v48, v48 quad_perm:[2,3,0,1] row_mask:0xf bank_mask:0xf
  s_nop 1
  v_add_f32_dpp v48, v48, v48 row_half_mirror row_mask:0xf bank_mask:0xf
  v_cvt_pk_bf16_f32 v48, v48, v48
  v_and_b32 v48, s72, v48
  v_mul_f32 v48, s66, v48
  v_cvt_pk_bf16_f32 v48, v48, v48
  v_and_b32 v245, s72, v48
  ds_write_b32 v252, v245 offset:148
  v_dot2_f32_bf16 v48, v112, v20, 0
  v_dot2_f32_bf16 v48, v113, v21, v48
  v_dot2_f32_bf16 v48, v114, v22, v48
  v_dot2_f32_bf16 v48, v115, v23, v48
  v_dot2_f32_bf16 v48, v116, v24, v48
  v_dot2_f32_bf16 v48, v117, v25, v48
  v_dot2_f32_bf16 v48, v118, v26, v48
  v_dot2_f32_bf16 v48, v119, v27, v48
  v_dot2_f32_bf16 v48, v120, v28, v48
  v_dot2_f32_bf16 v48, v121, v29, v48
  v_dot2_f32_bf16 v48, v122, v30, v48
  v_dot2_f32_bf16 v48, v123, v31, v48
  s_nop 2
  v_add_f32_dpp v48, v48, v48 quad_perm:[1,0,3,2] row_mask:0xf bank_mask:0xf
  s_nop 1
  v_add_f32_dpp v48, v48, v48 quad_perm:[2,3,0,1] row_mask:0xf bank_mask:0xf
  s_nop 1
  v_add_f32_dpp v48, v48, v48 row_half_mirror row_mask:0xf bank_mask:0xf
  v_cvt_pk_bf16_f32 v48, v48, v48
  v_and_b32 v48, s72, v48
  v_mul_f32 v48, s66, v48
  v_cvt_pk_bf16_f32 v48, v48, v48
  v_and_b32 v49, s72, v48
  ds_write_b32 v252, v49 offset:0
  v_dot2_f32_bf16 v48, v124, v20, 0
  v_dot2_f32_bf16 v48, v125, v21, v48
  v_dot2_f32_bf16 v48, v126, v22, v48
  v_dot2_f32_bf16 v48, v127, v23, v48
  v_dot2_f32_bf16 v48, v128, v24, v48
  v_dot2_f32_bf16 v48, v129, v25, v48
  v_dot2_f32_bf16 v48, v130, v26, v48
  v_dot2_f32_bf16 v48, v131, v27, v48
  v_dot2_f32_bf16 v48, v132, v28, v48
  v_dot2_f32_bf16 v48, v133, v29, v48
  v_dot2_f32_bf16 v48, v134, v30, v48
  v_dot2_f32_bf16 v48, v135, v31, v48
  s_nop 2
  v_add_f32_dpp v48, v48, v48 quad_perm:[1,0,3,2] row_mask:0xf bank_mask:0xf
  s_nop 1
  v_add_f32_dpp v48, v48, v48 quad_perm:[2,3,0,1] row_mask:0xf bank_mask:0xf
  s_nop 1
  v_add_f32_dpp v48, v48, v48 row_half_mirror row_mask:0xf bank_mask:0xf
  v_cvt_pk_bf16_f32 v48, v48, v48
  v_and_b32 v48, s72, v48
  v_mul_f32 v48, s66, v48
  v_cvt_pk_bf16_f32 v48, v48, v48
  v_and_b32 v49, s72, v48
  ds_write_b32 v252, v49 offset:4
  s_waitcnt vmcnt(7)
  s_and_b32 s60, s61, 0xffff
  s_mul_i32 s60, s60, 384
  buffer_load_dwordx4 v[64:67], v10, s[8:11], s60 offen nt
  v_dot2_f32_bf16 v48, v88, v20, 0
  v_dot2_f32_bf16 v48, v89, v21, v48
  v_dot2_f32_bf16 v48, v90, v22, v48
  v_dot2_f32_bf16 v48, v91, v23, v48
  s_waitcnt vmcnt(7)
  buffer_load_dwordx4 v[68:71], v10, s[8:11], s60 offen offset:128 nt
  v_dot2_f32_bf16 v48, v92, v24, v48
  v_dot2_f32_bf16 v48, v93, v25, v48
  v_dot2_f32_bf16 v48, v94, v26, v48
  v_dot2_f32_bf16 v48, v95, v27, v48
  s_waitcnt vmcnt(7)
  buffer_load_dwordx4 a[8:11], v55, s[20:23], s71 offen offset:2048 nt
  s_waitcnt vmcnt(7)
  buffer_load_dwordx4 v[72:75], v11, s[8:11], s60 offen nt
  v_dot2_f32_bf16 v48, v96, v28, v48
  v_dot2_f32_bf16 v48, v97, v29, v48
  v_dot2_f32_bf16 v48, v98, v30, v48
  v_dot2_f32_bf16 v48, v99, v31, v48
  s_nop 2
  v_add_f32_dpp v48, v48, v48 quad_perm:[1,0,3,2] row_mask:0xf bank_mask:0xf
  s_nop 1
  v_add_f32_dpp v48, v48, v48 quad_perm:[2,3,0,1] row_mask:0xf bank_mask:0xf
  s_nop 1
  v_add_f32_dpp v48, v48, v48 row_half_mirror row_mask:0xf bank_mask:0xf
  v_cvt_pk_bf16_f32 v48, v48, v48
  v_and_b32 v48, s72, v48
  v_mul_f32 v48, s66, v48
  v_cvt_pk_bf16_f32 v48, v48, v48
  v_and_b32 v246, s72, v48
  ds_write_b32 v252, v246 offset:152
  v_dot2_f32_bf16 v48, v136, v20, 0
  v_dot2_f32_bf16 v48, v137, v21, v48
  v_dot2_f32_bf16 v48, v138, v22, v48
  v_dot2_f32_bf16 v48, v139, v23, v48
  v_dot2_f32_bf16 v48, v140, v24, v48
  v_dot2_f32_bf16 v48, v141, v25, v48
  v_dot2_f32_bf16 v48, v142, v26, v48
  v_dot2_f32_bf16 v48, v143, v27, v48
  v_dot2_f32_bf16 v48, v144, v28, v48
  v_dot2_f32_bf16 v48, v145, v29, v48
  v_dot2_f32_bf16 v48, v146, v30, v48
  v_dot2_f32_bf16 v48, v147, v31, v48
  s_nop 2
  v_add_f32_dpp v48, v48, v48 quad_perm:[1,0,3,2] row_mask:0xf bank_mask:0xf
  s_nop 1
  v_add_f32_dpp v48, v48, v48 quad_perm:[2,3,0,1] row_mask:0xf bank_mask:0xf
  s_nop 1
  v_add_f32_dpp v48, v48, v48 row_half_mirror row_mask:0xf bank_mask:0xf
  v_cvt_pk_bf16_f32 v48, v48, v48
  v_and_b32 v48, s72, v48
  v_mul_f32 v48, s66, v48
  v_cvt_pk_bf16_f32 v48, v48, v48
  v_and_b32 v49, s72, v48
  ds_write_b32 v252, v49 offset:8
  v_dot2_f32_bf16 v48, v148, v20, 0
  v_dot2_f32_bf16 v48, v149, v21, v48
  v_dot2_f32_bf16 v48, v150, v22, v48
  v_dot2_f32_bf16 v48, v151, v23, v48
  v_dot2_f32_bf16 v48, v152, v24, v48
  v_dot2_f32_bf16 v48, v153, v25, v48
  v_dot2_f32_bf16 v48, v154, v26, v48
  v_dot2_f32_bf16 v48, v155, v27, v48
  v_dot2_f32_bf16 v48, v156, v28, v48
  v_dot2_f32_bf16 v48, v157, v29, v48
  v_dot2_f32_bf16 v48, v158, v30, v48
  v_dot2_f32_bf16 v48, v159, v31, v48
  s_nop 2
  v_add_f32_dpp v48, v48, v48 quad_perm:[1,0,3,2] row_mask:0xf bank_mask:0xf
  s_nop 1
  v_add_f32_dpp v48, v48, v48 quad_perm:[2,3,0,1] row_mask:0xf bank_mask:0xf
  s_nop 1
  v_add_f32_dpp v48, v48, v48 row_half_mirror row_mask:0xf bank_mask:0xf
  v_cvt_pk_bf16_f32 v48, v48, v48
  v_and_b32 v48, s72, v48
  v_mul_f32 v48, s66, v48
  v_cvt_pk_bf16_f32 v48, v48, v48
  v_and_b32 v49, s72, v48
  ds_write_b32 v252, v49 offset:12
  s_waitcnt vmcnt(7)
  s_lshr_b32 s60, s61, 16
  s_mul_i32 s60, s60, 384
  buffer_load_dwordx4 v[76:79], v10, s[8:11], s60 offen nt
  v_dot2_f32_bf16 v48, v100, v20, 0
  v_dot2_f32_bf16 v48, v101, v21, v48
  v_dot2_f32_bf16 v48, v102, v22, v48
  v_dot2_f32_bf16 v48, v103, v23, v48
  s_waitcnt vmcnt(7)
  v_readlane_b32 s61, v14, 20
  buffer_load_dwordx4 v[80:83], v10, s[8:11], s60 offen offset:128 nt
  v_dot2_f32_bf16 v48, v104, v24, v48
  v_dot2_f32_bf16 v48, v105, v25, v48
  v_dot2_f32_bf16 v48, v106, v26, v48
  v_dot2_f32_bf16 v48, v107, v27, v48
  s_waitcnt vmcnt(7)
  buffer_load_dwordx4 a[12:15], v55, s[20:23], s71 offen offset:2304 nt
  s_waitcnt vmcnt(7)
  buffer_load_dwordx4 v[84:87], v11, s[8:11], s60 offen nt
  v_dot2_f32_bf16 v48, v108, v28, v48
  v_dot2_f32_bf16 v48, v109, v29, v48
  v_dot2_f32_bf16 v48, v110, v30, v48
  v_dot2_f32_bf16 v48, v111, v31, v48
  s_nop 2
  v_add_f32_dpp v48, v48, v48 quad_perm:[1,0,3,2] row_mask:0xf bank_mask:0xf
  s_nop 1
  v_add_f32_dpp v48, v48, v48 quad_perm:[2,3,0,1] row_mask:0xf bank_mask:0xf
  s_nop 1
  v_add_f32_dpp v48, v48, v48 row_half_mirror row_mask:0xf bank_mask:0xf
  v_cvt_pk_bf16_f32 v48, v48, v48
  v_and_b32 v48, s72, v48
  v_mul_f32 v48, s66, v48
  v_cvt_pk_bf16_f32 v48, v48, v48
  v_and_b32 v247, s72, v48
  ds_write_b32 v252, v247 offset:156
  v_dot2_f32_bf16 v48, v160, v20, 0
  v_dot2_f32_bf16 v48, v161, v21, v48
  v_dot2_f32_bf16 v48, v162, v22, v48
  v_dot2_f32_bf16 v48, v163, v23, v48
  v_dot2_f32_bf16 v48, v164, v24, v48
  v_dot2_f32_bf16 v48, v165, v25, v48
  v_dot2_f32_bf16 v48, v166, v26, v48
  v_dot2_f32_bf16 v48, v167, v27, v48
  v_dot2_f32_bf16 v48, v168, v28, v48
  v_dot2_f32_bf16 v48, v169, v29, v48
  v_dot2_f32_bf16 v48, v170, v30, v48
  v_dot2_f32_bf16 v48, v171, v31, v48
  s_nop 2
  v_add_f32_dpp v48, v48, v48 quad_perm:[1,0,3,2] row_mask:0xf bank_mask:0xf
  s_nop 1
  v_add_f32_dpp v48, v48, v48 quad_perm:[2,3,0,1] row_mask:0xf bank_mask:0xf
  s_nop 1
  v_add_f32_dpp v48, v48, v48 row_half_mirror row_mask:0xf bank_mask:0xf
  v_cvt_pk_bf16_f32 v48, v48, v48
  v_and_b32 v48, s72, v48
  v_mul_f32 v48, s66, v48
  v_cvt_pk_bf16_f32 v48, v48, v48
  v_and_b32 v49, s72, v48
  ds_write_b32 v252, v49 offset:16
  v_dot2_f32_bf16 v48, v172, v20, 0
  v_dot2_f32_bf16 v48, v173, v21, v48
  v_dot2_f32_bf16 v48, v174, v22, v48
  v_dot2_f32_bf16 v48, v175, v23, v48
  v_dot2_f32_bf16 v48, v176, v24, v48
  v_dot2_f32_bf16 v48, v177, v25, v48
  v_dot2_f32_bf16 v48, v178, v26, v48
  v_dot2_f32_bf16 v48, v179, v27, v48
  v_dot2_f32_bf16 v48, v180, v28, v48
  v_dot2_f32_bf16 v48, v181, v29, v48
  v_dot2_f32_bf16 v48, v182, v30, v48
  v_dot2_f32_bf16 v48, v183, v31, v48
  s_nop 2
  v_add_f32_dpp v48, v48, v48 quad_perm:[1,0,3,2] row_mask:0xf bank_mask:0xf
  s_nop 1
  v_add_f32_dpp v48, v48, v48 quad_perm:[2,3,0,1] row_mask:0xf bank_mask:0xf
  s_nop 1
  v_add_f32_dpp v48, v48, v48 row_half_mirror row_mask:0xf bank_mask:0xf
  v_cvt_pk_bf16_f32 v48, v48, v48
  v_and_b32 v48, s72, v48
  v_mul_f32 v48, s66, v48
  v_cvt_pk_bf16_f32 v48, v48, v48
  v_and_b32 v49, s72, v48
  ds_write_b32 v252, v49 offset:20
  s_waitcnt vmcnt(7)
  s_and_b32 s60, s61, 0xffff
  s_mul_i32 s60, s60, 384
  buffer_load_dwordx4 v[88:91], v10, s[8:11], s60 offen nt
  v_dot2_f32_bf16 v48, v64, v20, 0
  v_dot2_f32_bf16 v48, v65, v21, v48
  v_dot2_f32_bf16 v48, v66, v22, v48
  v_dot2_f32_bf16 v48, v67, v23, v48
  s_waitcnt vmcnt(7)
  buffer_load_dwordx4 v[92:95], v10, s[8:11], s60 offen offset:128 nt
  v_dot2_f32_bf16 v48, v68, v24, v48
  v_dot2_f32_bf16 v48, v69, v25, v48
  v_dot2_f32_bf16 v48, v70, v26, v48
  v_dot2_f32_bf16 v48, v71, v27, v48
  s_waitcnt vmcnt(7)
  buffer_load_dwordx4 a[16:19], v55, s[20:23], s71 offen offset:2560 nt
  s_waitcnt vmcnt(7)
  buffer_load_dwordx4 v[96:99], v11, s[8:11], s60 offen nt
  v_dot2_f32_bf16 v48, v72, v28, v48
  v_dot2_f32_bf16 v48, v73, v29, v48
  v_dot2_f32_bf16 v48, v74, v30, v48
  v_dot2_f32_bf16 v48, v75, v31, v48
  s_nop 2
  v_add_f32_dpp v48, v48, v48 quad_perm:[1,0,3,2] row_mask:0xf bank_mask:0xf
  s_nop 1
  v_add_f32_dpp v48, v48, v48 quad_perm:[2,3,0,1] row_mask:0xf bank_mask:0xf
  s_nop 1
  v_add_f32_dpp v48, v48, v48 row_half_mirror row_mask:0xf bank_mask:0xf
  v_cvt_pk_bf16_f32 v48, v48, v48
  v_and_b32 v48, s72, v48
  v_mul_f32 v48, s66, v48
  v_cvt_pk_bf16_f32 v48, v48, v48
  v_and_b32 v244, s72, v48
  ds_write_b32 v252, v244 offset:160
  v_dot2_f32_bf16 v48, v184, v20, 0
  v_dot2_f32_bf16 v48, v185, v21, v48
  v_dot2_f32_bf16 v48, v186, v22, v48
  v_dot2_f32_bf16 v48, v187, v23, v48
  v_dot2_f32_bf16 v48, v188, v24, v48
  v_dot2_f32_bf16 v48, v189, v25, v48
  v_dot2_f32_bf16 v48, v190, v26, v48
  v_dot2_f32_bf16 v48, v191, v27, v48
  v_dot2_f32_bf16 v48, v192, v28, v48
  v_dot2_f32_bf16 v48, v193, v29, v48
  v_dot2_f32_bf16 v48, v194, v30, v48
  v_dot2_f32_bf16 v48, v195, v31, v48
  s_nop 2
  v_add_f32_dpp v48, v48, v48 quad_perm:[1,0,3,2] row_mask:0xf bank_mask:0xf
  s_nop 1
  v_add_f32_dpp v48, v48, v48 quad_perm:[2,3,0,1] row_mask:0xf bank_mask:0xf
  s_nop 1
  v_add_f32_dpp v48, v48, v48 row_half_mirror row_mask:0xf bank_mask:0xf
  v_cvt_pk_bf16_f32 v48, v48, v48
  v_and_b32 v48, s72, v48
  v_mul_f32 v48, s66, v48
  v_cvt_pk_bf16_f32 v48, v48, v48
  v_and_b32 v49, s72, v48
  ds_write_b32 v252, v49 offset:24
  v_dot2_f32_bf16 v48, v196, v20, 0
  v_dot2_f32_bf16 v48, v197, v21, v48
  v_dot2_f32_bf16 v48, v198, v22, v48
  v_dot2_f32_bf16 v48, v199, v23, v48
  v_dot2_f32_bf16 v48, v200, v24, v48
  v_dot2_f32_bf16 v48, v201, v25, v48
  v_dot2_f32_bf16 v48, v202, v26, v48
  v_dot2_f32_bf16 v48, v203, v27, v48
  v_dot2_f32_bf16 v48, v204, v28, v48
  v_dot2_f32_bf16 v48, v205, v29, v48
  v_dot2_f32_bf16 v48, v206, v30, v48
  v_dot2_f32_bf16 v48, v207, v31, v48
  s_nop 2
  v_add_f32_dpp v48, v48, v48 quad_perm:[1,0,3,2] row_mask:0xf bank_mask:0xf
  s_nop 1
  v_add_f32_dpp v48, v48, v48 quad_perm:[2,3,0,1] row_mask:0xf bank_mask:0xf
  s_nop 1
  v_add_f32_dpp v48, v48, v48 row_half_mirror row_mask:0xf bank_mask:0xf
  v_cvt_pk_bf16_f32 v48, v48, v48
  v_and_b32 v48, s72, v48
  v_mul_f32 v48, s66, v48
  v_cvt_pk_bf16_f32 v48, v48, v48
  v_and_b32 v49, s72, v48
  ds_write_b32 v252, v49 offset:28
  s_waitcnt vmcnt(7)
  s_lshr_b32 s60, s61, 16
  s_mul_i32 s60, s60, 384
  buffer_load_dwordx4 v[100:103], v10, s[8:11], s60 offen nt
  v_dot2_f32_bf16 v48, v76, v20, 0
  v_dot2_f32_bf16 v48, v77, v21, v48
  v_dot2_f32_bf16 v48, v78, v22, v48
  v_dot2_f32_bf16 v48, v79, v23, v48
  s_waitcnt vmcnt(7)
  v_readlane_b32 s61, v14, 21
  buffer_load_dwordx4 v[104:107], v10, s[8:11], s60 offen offset:128 nt
  v_dot2_f32_bf16 v48, v80, v24, v48
  v_dot2_f32_bf16 v48, v81, v25, v48
  v_dot2_f32_bf16 v48, v82, v26, v48
  v_dot2_f32_bf16 v48, v83, v27, v48
  s_waitcnt vmcnt(7)
  buffer_load_dwordx4 a[20:23], v55, s[20:23], s71 offen offset:2816 nt
  s_waitcnt vmcnt(7)
  buffer_load_dwordx4 v[108:111], v11, s[8:11], s60 offen nt
  v_dot2_f32_bf16 v48, v84, v28, v48
  v_dot2_f32_bf16 v48, v85, v29, v48
  v_dot2_f32_bf16 v48, v86, v30, v48
  v_dot2_f32_bf16 v48, v87, v31, v48
  s_nop 2
  v_add_f32_dpp v48, v48, v48 quad_perm:[1,0,3,2] row_mask:0xf bank_mask:0xf
  s_nop 1
  v_add_f32_dpp v48, v48, v48 quad_perm:[2,3,0,1] row_mask:0xf bank_mask:0xf
  s_nop 1
  v_add_f32_dpp v48, v48, v48 row_half_mirror row_mask:0xf bank_mask:0xf
  v_cvt_pk_bf16_f32 v48, v48, v48
  v_and_b32 v48, s72, v48
  v_mul_f32 v48, s66, v48
  v_cvt_pk_bf16_f32 v48, v48, v48
  v_and_b32 v245, s72, v48
  ds_write_b32 v252, v245 offset:164
  v_dot2_f32_bf16 v48, v208, v20, 0
  v_dot2_f32_bf16 v48, v209, v21, v48
  v_dot2_f32_bf16 v48, v210, v22, v48
  v_dot2_f32_bf16 v48, v211, v23, v48
  v_dot2_f32_bf16 v48, v212, v24, v48
  v_dot2_f32_bf16 v48, v213, v25, v48
  v_dot2_f32_bf16 v48, v214, v26, v48
  v_dot2_f32_bf16 v48, v215, v27, v48
  v_dot2_f32_bf16 v48, v216, v28, v48
  v_dot2_f32_bf16 v48, v217, v29, v48
  v_dot2_f32_bf16 v48, v218, v30, v48
  v_dot2_f32_bf16 v48, v219, v31, v48
  s_nop 2
  v_add_f32_dpp v48, v48, v48 quad_perm:[1,0,3,2] row_mask:0xf bank_mask:0xf
  s_nop 1
  v_add_f32_dpp v48, v48, v48 quad_perm:[2,3,0,1] row_mask:0xf bank_mask:0xf
  s_nop 1
  v_add_f32_dpp v48, v48, v48 row_half_mirror row_mask:0xf bank_mask:0xf
  v_cvt_pk_bf16_f32 v48, v48, v48
  v_and_b32 v48, s72, v48
  v_mul_f32 v48, s66, v48
  v_cvt_pk_bf16_f32 v48, v48, v48
  v_and_b32 v49, s72, v48
  ds_write_b32 v252, v49 offset:32
  v_dot2_f32_bf16 v48, v220, v20, 0
  v_dot2_f32_bf16 v48, v221, v21, v48
  v_dot2_f32_bf16 v48, v222, v22, v48
  v_dot2_f32_bf16 v48, v223, v23, v48
  v_dot2_f32_bf16 v48, v224, v24, v48
  v_dot2_f32_bf16 v48, v225, v25, v48
  v_dot2_f32_bf16 v48, v226, v26, v48
  v_dot2_f32_bf16 v48, v227, v27, v48
  v_dot2_f32_bf16 v48, v228, v28, v48
  v_dot2_f32_bf16 v48, v229, v29, v48
  v_dot2_f32_bf16 v48, v230, v30, v48
  v_dot2_f32_bf16 v48, v231, v31, v48
  s_nop 2
  v_add_f32_dpp v48, v48, v48 quad_perm:[1,0,3,2] row_mask:0xf bank_mask:0xf
  s_nop 1
  v_add_f32_dpp v48, v48, v48 quad_perm:[2,3,0,1] row_mask:0xf bank_mask:0xf
  s_nop 1
  v_add_f32_dpp v48, v48, v48 row_half_mirror row_mask:0xf bank_mask:0xf
  v_cvt_pk_bf16_f32 v48, v48, v48
  v_and_b32 v48, s72, v48
  v_mul_f32 v48, s66, v48
  v_cvt_pk_bf16_f32 v48, v48, v48
  v_and_b32 v49, s72, v48
  ds_write_b32 v252, v49 offset:36
  s_waitcnt vmcnt(7)
  s_and_b32 s60, s61, 0xffff
  s_mul_i32 s60, s60, 384
  buffer_load_dwordx4 v[64:67], v10, s[8:11], s60 offen nt
  v_dot2_f32_bf16 v48, v88, v20, 0
  v_dot2_f32_bf16 v48, v89, v21, v48
  v_dot2_f32_bf16 v48, v90, v22, v48
  v_dot2_f32_bf16 v48, v91, v23, v48
  s_waitcnt vmcnt(7)
  buffer_load_dwordx4 v[68:71], v10, s[8:11], s60 offen offset:128 nt
  v_dot2_f32_bf16 v48, v92, v24, v48
  v_dot2_f32_bf16 v48, v93, v25, v48
  v_dot2_f32_bf16 v48, v94, v26, v48
  v_dot2_f32_bf16 v48, v95, v27, v48
  s_waitcnt vmcnt(7)
  buffer_load_dwordx4 a[24:27], v55, s[20:23], s71 offen offset:3072 nt
  s_waitcnt vmcnt(7)
  buffer_load_dwordx4 v[72:75], v11, s[8:11], s60 offen nt
  v_dot2_f32_bf16 v48, v96, v28, v48
  v_dot2_f32_bf16 v48, v97, v29, v48
  v_dot2_f32_bf16 v48, v98, v30, v48
  v_dot2_f32_bf16 v48, v99, v31, v48
  s_nop 2
  v_add_f32_dpp v48, v48, v48 quad_perm:[1,0,3,2] row_mask:0xf bank_mask:0xf
  s_nop 1
  v_add_f32_dpp v48, v48, v48 quad_perm:[2,3,0,1] row_mask:0xf bank_mask:0xf
  s_nop 1
  v_add_f32_dpp v48, v48, v48 row_half_mirror row_mask:0xf bank_mask:0xf
  v_cvt_pk_bf16_f32 v48, v48, v48
  v_and_b32 v48, s72, v48
  v_mul_f32 v48, s66, v48
  v_cvt_pk_bf16_f32 v48, v48, v48
  v_and_b32 v246, s72, v48
  ds_write_b32 v252, v246 offset:168
  s_waitcnt vmcnt(7)
  s_lshr_b32 s60, s61, 16
  s_mul_i32 s60, s60, 384
  buffer_load_dwordx4 v[76:79], v10, s[8:11], s60 offen nt
  v_dot2_f32_bf16 v48, v100, v20, 0
  v_dot2_f32_bf16 v48, v101, v21, v48
  v_dot2_f32_bf16 v48, v102, v22, v48
  v_dot2_f32_bf16 v48, v103, v23, v48
  s_waitcnt vmcnt(7)
  v_readlane_b32 s61, v14, 22
  buffer_load_dwordx4 v[80:83], v10, s[8:11], s60 offen offset:128 nt
  v_dot2_f32_bf16 v48, v104, v24, v48
  v_dot2_f32_bf16 v48, v105, v25, v48
  v_dot2_f32_bf16 v48, v106, v26, v48
  v_dot2_f32_bf16 v48, v107, v27, v48
  s_waitcnt vmcnt(7)
  buffer_load_dwordx4 a[28:31], v55, s[20:23], s71 offen offset:3328 nt
  s_waitcnt vmcnt(7)
  buffer_load_dwordx4 v[84:87], v11, s[8:11], s60 offen nt
  v_dot2_f32_bf16 v48, v108, v28, v48
  v_dot2_f32_bf16 v48, v109, v29, v48
  v_dot2_f32_bf16 v48, v110, v30, v48
  v_dot2_f32_bf16 v48, v111, v31, v48
  s_nop 2
  v_add_f32_dpp v48, v48, v48 quad_perm:[1,0,3,2] row_mask:0xf bank_mask:0xf
  s_nop 1
  v_add_f32_dpp v48, v48, v48 quad_perm:[2,3,0,1] row_mask:0xf bank_mask:0xf
  s_nop 1
  v_add_f32_dpp v48, v48, v48 row_half_mirror row_mask:0xf bank_mask:0xf
  v_cvt_pk_bf16_f32 v48, v48, v48
  v_and_b32 v48, s72, v48
  v_mul_f32 v48, s66, v48
  v_cvt_pk_bf16_f32 v48, v48, v48
  v_and_b32 v247, s72, v48
  ds_write_b32 v252, v247 offset:172
  s_waitcnt vmcnt(7)
  s_and_b32 s60, s61, 0xffff
  s_mul_i32 s60, s60, 384
  buffer_load_dwordx4 v[88:91], v10, s[8:11], s60 offen nt
  v_dot2_f32_bf16 v48, v64, v20, 0
  v_dot2_f32_bf16 v48, v65, v21, v48
  v_dot2_f32_bf16 v48, v66, v22, v48
  v_dot2_f32_bf16 v48, v67, v23, v48
  s_waitcnt vmcnt(7)
  buffer_load_dwordx4 v[92:95], v10, s[8:11], s60 offen offset:128 nt
  v_dot2_f32_bf16 v48, v68, v24, v48
  v_dot2_f32_bf16 v48, v69, v25, v48
  v_dot2_f32_bf16 v48, v70, v26, v48
  v_dot2_f32_bf16 v48, v71, v27, v48
  s_waitcnt vmcnt(7)
  buffer_load_dwordx4 a[32:35], v55, s[20:23], s71 offen offset:3584 nt
  s_waitcnt vmcnt(7)
  buffer_load_dwordx4 v[96:99], v11, s[8:11], s60 offen nt
  v_dot2_f32_bf16 v48, v72, v28, v48
  v_dot2_f32_bf16 v48, v73, v29, v48
  v_dot2_f32_bf16 v48, v74, v30, v48
  v_dot2_f32_bf16 v48, v75, v31, v48
  s_nop 2
  v_add_f32_dpp v48, v48, v48 quad_perm:[1,0,3,2] row_mask:0xf bank_mask:0xf
  s_nop 1
  v_add_f32_dpp v48, v48, v48 quad_perm:[2,3,0,1] row_mask:0xf bank_mask:0xf
  s_nop 1
  v_add_f32_dpp v48, v48, v48 row_half_mirror row_mask:0xf bank_mask:0xf
  v_cvt_pk_bf16_f32 v48, v48, v48
  v_and_b32 v48, s72, v48
  v_mul_f32 v48, s66, v48
  v_cvt_pk_bf16_f32 v48, v48, v48
  v_and_b32 v244, s72, v48
  ds_write_b32 v252, v244 offset:176
  s_waitcnt vmcnt(7)
  s_lshr_b32 s60, s61, 16
  s_mul_i32 s60, s60, 384
  buffer_load_dwordx4 v[100:103], v10, s[8:11], s60 offen nt
  v_dot2_f32_bf16 v48, v76, v20, 0
  v_dot2_f32_bf16 v48, v77, v21, v48
  v_dot2_f32_bf16 v48, v78, v22, v48
  v_dot2_f32_bf16 v48, v79, v23, v48
  s_waitcnt vmcnt(7)
  v_readlane_b32 s61, v14, 23
  buffer_load_dwordx4 v[104:107], v10, s[8:11], s60 offen offset:128 nt
  v_dot2_f32_bf16 v48, v80, v24, v48
  v_dot2_f32_bf16 v48, v81, v25, v48
  v_dot2_f32_bf16 v48, v82, v26, v48
  v_dot2_f32_bf16 v48, v83, v27, v48
  s_waitcnt vmcnt(7)
  s_mov_b32 s71, 3840
  buffer_load_dwordx4 a[36:39], v55, s[20:23], s71 offen nt
  s_waitcnt vmcnt(7)
  buffer_load_dwordx4 v[108:111], v11, s[8:11], s60 offen nt
  v_dot2_f32_bf16 v48, v84, v28, v48
  v_dot2_f32_bf16 v48, v85, v29, v48
  v_dot2_f32_bf16 v48, v86, v30, v48
  v_dot2_f32_bf16 v48, v87, v31, v48
  s_nop 2
  v_add_f32_dpp v48, v48, v48 quad_perm:[1,0,3,2] row_mask:0xf bank_mask:0xf
  s_nop 1
  v_add_f32_dpp v48, v48, v48 quad_perm:[2,3,0,1] row_mask:0xf bank_mask:0xf
  s_nop 1
  v_add_f32_dpp v48, v48, v48 row_half_mirror row_mask:0xf bank_mask:0xf
  v_cvt_pk_bf16_f32 v48, v48, v48
  v_and_b32 v48, s72, v48
  v_mul_f32 v48, s66, v48
  v_cvt_pk_bf16_f32 v48, v48, v48
  v_and_b32 v245, s72, v48
  ds_write_b32 v252, v245 offset:180
  s_waitcnt vmcnt(7)
  s_and_b32 s60, s61, 0xffff
  s_mul_i32 s60, s60, 384
  buffer_load_dwordx4 v[64:67], v10, s[8:11], s60 offen nt
  v_dot2_f32_bf16 v48, v88, v20, 0
  v_dot2_f32_bf16 v48, v89, v21, v48
  v_dot2_f32_bf16 v48, v90, v22, v48
  v_dot2_f32_bf16 v48, v91, v23, v48
  s_waitcnt vmcnt(7)
  buffer_load_dwordx4 v[68:71], v10, s[8:11], s60 offen offset:128 nt
  v_dot2_f32_bf16 v48, v92, v24, v48
  v_dot2_f32_bf16 v48, v93, v25, v48
  v_dot2_f32_bf16 v48, v94, v26, v48
  v_dot2_f32_bf16 v48, v95, v27, v48
  s_waitcnt vmcnt(7)
  buffer_load_dwordx4 a[40:43], v55, s[20:23], s71 offen offset:256 nt
  s_waitcnt vmcnt(7)
  buffer_load_dwordx4 v[72:75], v11, s[8:11], s60 offen nt
  v_dot2_f32_bf16 v48, v96, v28, v48
  v_dot2_f32_bf16 v48, v97, v29, v48
  v_dot2_f32_bf16 v48, v98, v30, v48
  v_dot2_f32_bf16 v48, v99, v31, v48
  s_nop 2
  v_add_f32_dpp v48, v48, v48 quad_perm:[1,0,3,2] row_mask:0xf bank_mask:0xf
  s_nop 1
  v_add_f32_dpp v48, v48, v48 quad_perm:[2,3,0,1] row_mask:0xf bank_mask:0xf
  s_nop 1
  v_add_f32_dpp v48, v48, v48 row_half_mirror row_mask:0xf bank_mask:0xf
  v_cvt_pk_bf16_f32 v48, v48, v48
  v_and_b32 v48, s72, v48
  v_mul_f32 v48, s66, v48
  v_cvt_pk_bf16_f32 v48, v48, v48
  v_and_b32 v246, s72, v48
  ds_write_b32 v252, v246 offset:184
  s_waitcnt vmcnt(7)
  s_lshr_b32 s60, s61, 16
  s_mul_i32 s60, s60, 384
  buffer_load_dwordx4 v[76:79], v10, s[8:11], s60 offen nt
  v_dot2_f32_bf16 v48, v100, v20, 0
  v_dot2_f32_bf16 v48, v101, v21, v48
  v_dot2_f32_bf16 v48, v102, v22, v48
  v_dot2_f32_bf16 v48, v103, v23, v48
  s_waitcnt vmcnt(7)
  v_readlane_b32 s61, v14, 24
  buffer_load_dwordx4 v[80:83], v10, s[8:11], s60 offen offset:128 nt
  v_dot2_f32_bf16 v48, v104, v24, v48
  v_dot2_f32_bf16 v48, v105, v25, v48
  v_dot2_f32_bf16 v48, v106, v26, v48
  v_dot2_f32_bf16 v48, v107, v27, v48
  s_waitcnt vmcnt(7)
  buffer_load_dwordx4 a[44:47], v55, s[20:23], s71 offen offset:512 nt
  s_waitcnt vmcnt(7)
  buffer_load_dwordx4 v[84:87], v11, s[8:11], s60 offen nt
  v_dot2_f32_bf16 v48, v108, v28, v48
  v_dot2_f32_bf16 v48, v109, v29, v48
  v_dot2_f32_bf16 v48, v110, v30, v48
  v_dot2_f32_bf16 v48, v111, v31, v48
  s_nop 2
  v_add_f32_dpp v48, v48, v48 quad_perm:[1,0,3,2] row_mask:0xf bank_mask:0xf
  s_nop 1
  v_add_f32_dpp v48, v48, v48 quad_perm:[2,3,0,1] row_mask:0xf bank_mask:0xf
  s_nop 1
  v_add_f32_dpp v48, v48, v48 row_half_mirror row_mask:0xf bank_mask:0xf
  v_cvt_pk_bf16_f32 v48, v48, v48
  v_and_b32 v48, s72, v48
  v_mul_f32 v48, s66, v48
  v_cvt_pk_bf16_f32 v48, v48, v48
  v_and_b32 v247, s72, v48
  ds_write_b32 v252, v247 offset:188
  s_waitcnt vmcnt(7)
  s_and_b32 s60, s61, 0xffff
  s_mul_i32 s60, s60, 384
  buffer_load_dwordx4 v[88:91], v10, s[8:11], s60 offen nt
  v_dot2_f32_bf16 v48, v64, v20, 0
  v_dot2_f32_bf16 v48, v65, v21, v48
  v_dot2_f32_bf16 v48, v66, v22, v48
  v_dot2_f32_bf16 v48, v67, v23, v48
  s_waitcnt vmcnt(7)
  buffer_load_dwordx4 v[92:95], v10, s[8:11], s60 offen offset:128 nt
  v_dot2_f32_bf16 v48, v68, v24, v48
  v_dot2_f32_bf16 v48, v69, v25, v48
  v_dot2_f32_bf16 v48, v70, v26, v48
  v_dot2_f32_bf16 v48, v71, v27, v48
  s_waitcnt vmcnt(7)
  buffer_load_dwordx4 a[48:51], v55, s[20:23], s71 offen offset:768 nt
  s_waitcnt vmcnt(7)
  buffer_load_dwordx4 v[96:99], v11, s[8:11], s60 offen nt
  v_dot2_f32_bf16 v48, v72, v28, v48
  v_dot2_f32_bf16 v48, v73, v29, v48
  v_dot2_f32_bf16 v48, v74, v30, v48
  v_dot2_f32_bf16 v48, v75, v31, v48
  s_nop 2
  v_add_f32_dpp v48, v48, v48 quad_perm:[1,0,3,2] row_mask:0xf bank_mask:0xf
  s_nop 1
  v_add_f32_dpp v48, v48, v48 quad_perm:[2,3,0,1] row_mask:0xf bank_mask:0xf
  s_nop 1
  v_add_f32_dpp v48, v48, v48 row_half_mirror row_mask:0xf bank_mask:0xf
  v_cvt_pk_bf16_f32 v48, v48, v48
  v_and_b32 v48, s72, v48
  v_mul_f32 v48, s66, v48
  v_cvt_pk_bf16_f32 v48, v48, v48
  v_and_b32 v244, s72, v48
  ds_write_b32 v252, v244 offset:192
  s_waitcnt vmcnt(7)
  s_lshr_b32 s60, s61, 16
  s_mul_i32 s60, s60, 384
  buffer_load_dwordx4 v[100:103], v10, s[8:11], s60 offen nt
  v_dot2_f32_bf16 v48, v76, v20, 0
  v_dot2_f32_bf16 v48, v77, v21, v48
  v_dot2_f32_bf16 v48, v78, v22, v48
  v_dot2_f32_bf16 v48, v79, v23, v48
  s_waitcnt vmcnt(7)
  v_readlane_b32 s61, v14, 25
  buffer_load_dwordx4 v[104:107], v10, s[8:11], s60 offen offset:128 nt
  v_dot2_f32_bf16 v48, v80, v24, v48
  v_dot2_f32_bf16 v48, v81, v25, v48
  v_dot2_f32_bf16 v48, v82, v26, v48
  v_dot2_f32_bf16 v48, v83, v27, v48
  s_waitcnt vmcnt(7)
  buffer_load_dwordx4 a[52:55], v55, s[20:23], s71 offen offset:1024 nt
  s_waitcnt vmcnt(7)
  buffer_load_dwordx4 v[108:111], v11, s[8:11], s60 offen nt
  v_dot2_f32_bf16 v48, v84, v28, v48
  v_dot2_f32_bf16 v48, v85, v29, v48
  v_dot2_f32_bf16 v48, v86, v30, v48
  v_dot2_f32_bf16 v48, v87, v31, v48
  s_nop 2
  v_add_f32_dpp v48, v48, v48 quad_perm:[1,0,3,2] row_mask:0xf bank_mask:0xf
  s_nop 1
  v_add_f32_dpp v48, v48, v48 quad_perm:[2,3,0,1] row_mask:0xf bank_mask:0xf
  s_nop 1
  v_add_f32_dpp v48, v48, v48 row_half_mirror row_mask:0xf bank_mask:0xf
  v_cvt_pk_bf16_f32 v48, v48, v48
  v_and_b32 v48, s72, v48
  v_mul_f32 v48, s66, v48
  v_cvt_pk_bf16_f32 v48, v48, v48
  v_and_b32 v245, s72, v48
  ds_write_b32 v252, v245 offset:196
  s_waitcnt vmcnt(7)
  s_and_b32 s60, s61, 0xffff
  s_mul_i32 s60, s60, 384
  buffer_load_dwordx4 v[64:67], v10, s[8:11], s60 offen nt
  v_dot2_f32_bf16 v48, v88, v20, 0
  v_dot2_f32_bf16 v48, v89, v21, v48
  v_dot2_f32_bf16 v48, v90, v22, v48
  v_dot2_f32_bf16 v48, v91, v23, v48
  s_waitcnt vmcnt(7)
  buffer_load_dwordx4 v[68:71], v10, s[8:11], s60 offen offset:128 nt
  v_dot2_f32_bf16 v48, v92, v24, v48
  v_dot2_f32_bf16 v48, v93, v25, v48
  v_dot2_f32_bf16 v48, v94, v26, v48
  v_dot2_f32_bf16 v48, v95, v27, v48
  s_waitcnt vmcnt(7)
  buffer_load_dwordx4 a[56:59], v55, s[20:23], s71 offen offset:1280 nt
  s_waitcnt vmcnt(7)
  buffer_load_dwordx4 v[72:75], v11, s[8:11], s60 offen nt
  v_dot2_f32_bf16 v48, v96, v28, v48
  v_dot2_f32_bf16 v48, v97, v29, v48
  v_dot2_f32_bf16 v48, v98, v30, v48
  v_dot2_f32_bf16 v48, v99, v31, v48
  s_nop 2
  v_add_f32_dpp v48, v48, v48 quad_perm:[1,0,3,2] row_mask:0xf bank_mask:0xf
  s_nop 1
  v_add_f32_dpp v48, v48, v48 quad_perm:[2,3,0,1] row_mask:0xf bank_mask:0xf
  s_nop 1
  v_add_f32_dpp v48, v48, v48 row_half_mirror row_mask:0xf bank_mask:0xf
  v_cvt_pk_bf16_f32 v48, v48, v48
  v_and_b32 v48, s72, v48
  v_mul_f32 v48, s66, v48
  v_cvt_pk_bf16_f32 v48, v48, v48
  v_and_b32 v246, s72, v48
  ds_write_b32 v252, v246 offset:200
  s_waitcnt vmcnt(7)
  s_lshr_b32 s60, s61, 16
  s_mul_i32 s60, s60, 384
  buffer_load_dwordx4 v[76:79], v10, s[8:11], s60 offen nt
  v_dot2_f32_bf16 v48, v100, v20, 0
  v_dot2_f32_bf16 v48, v101, v21, v48
  v_dot2_f32_bf16 v48, v102, v22, v48
  v_dot2_f32_bf16 v48, v103, v23, v48
  s_waitcnt vmcnt(7)
  v_readlane_b32 s61, v14, 26
  buffer_load_dwordx4 v[80:83], v10, s[8:11], s60 offen offset:128 nt
  v_dot2_f32_bf16 v48, v104, v24, v48
  v_dot2_f32_bf16 v48, v105, v25, v48
  v_dot2_f32_bf16 v48, v106, v26, v48
  v_dot2_f32_bf16 v48, v107, v27, v48
  s_waitcnt vmcnt(7)
  buffer_load_dwordx4 a[60:63], v55, s[20:23], s71 offen offset:1536 nt
  s_waitcnt vmcnt(7)
  buffer_load_dwordx4 v[84:87], v11, s[8:11], s60 offen nt
  v_dot2_f32_bf16 v48, v108, v28, v48
  v_dot2_f32_bf16 v48, v109, v29, v48
  v_dot2_f32_bf16 v48, v110, v30, v48
  v_dot2_f32_bf16 v48, v111, v31, v48
  s_nop 2
  v_add_f32_dpp v48, v48, v48 quad_perm:[1,0,3,2] row_mask:0xf bank_mask:0xf
  s_nop 1
  v_add_f32_dpp v48, v48, v48 quad_perm:[2,3,0,1] row_mask:0xf bank_mask:0xf
  s_nop 1
  v_add_f32_dpp v48, v48, v48 row_half_mirror row_mask:0xf bank_mask:0xf
  v_cvt_pk_bf16_f32 v48, v48, v48
  v_and_b32 v48, s72, v48
  v_mul_f32 v48, s66, v48
  v_cvt_pk_bf16_f32 v48, v48, v48
  v_and_b32 v247, s72, v48
  ds_write_b32 v252, v247 offset:204
  s_waitcnt vmcnt(7)
  s_and_b32 s60, s61, 0xffff
  s_mul_i32 s60, s60, 384
  buffer_load_dwordx4 v[88:91], v10, s[8:11], s60 offen nt
  v_dot2_f32_bf16 v48, v64, v20, 0
  v_dot2_f32_bf16 v48, v65, v21, v48
  v_dot2_f32_bf16 v48, v66, v22, v48
  v_dot2_f32_bf16 v48, v67, v23, v48
  s_waitcnt vmcnt(7)
  buffer_load_dwordx4 v[92:95], v10, s[8:11], s60 offen offset:128 nt
  v_dot2_f32_bf16 v48, v68, v24, v48
  v_dot2_f32_bf16 v48, v69, v25, v48
  v_dot2_f32_bf16 v48, v70, v26, v48
  v_dot2_f32_bf16 v48, v71, v27, v48
  s_waitcnt vmcnt(7)
  buffer_load_dwordx4 a[64:67], v55, s[20:23], s71 offen offset:1792 nt
  s_waitcnt vmcnt(7)
  buffer_load_dwordx4 v[96:99], v11, s[8:11], s60 offen nt
  v_dot2_f32_bf16 v48, v72, v28, v48
  v_dot2_f32_bf16 v48, v73, v29, v48
  v_dot2_f32_bf16 v48, v74, v30, v48
  v_dot2_f32_bf16 v48, v75, v31, v48
  s_nop 2
  v_add_f32_dpp v48, v48, v48 quad_perm:[1,0,3,2] row_mask:0xf bank_mask:0xf
  s_nop 1
  v_add_f32_dpp v48, v48, v48 quad_perm:[2,3,0,1] row_mask:0xf bank_mask:0xf
  s_nop 1
  v_add_f32_dpp v48, v48, v48 row_half_mirror row_mask:0xf bank_mask:0xf
  v_cvt_pk_bf16_f32 v48, v48, v48
  v_and_b32 v48, s72, v48
  v_mul_f32 v48, s66, v48
  v_cvt_pk_bf16_f32 v48, v48, v48
  v_and_b32 v244, s72, v48
  ds_write_b32 v252, v244 offset:208
  s_waitcnt vmcnt(7)
  s_lshr_b32 s60, s61, 16
  s_mul_i32 s60, s60, 384
  buffer_load_dwordx4 v[100:103], v10, s[8:11], s60 offen nt
  v_dot2_f32_bf16 v48, v76, v20, 0
  v_dot2_f32_bf16 v48, v77, v21, v48
  v_dot2_f32_bf16 v48, v78, v22, v48
  v_dot2_f32_bf16 v48, v79, v23, v48
  s_waitcnt vmcnt(7)
  v_readlane_b32 s61, v14, 27
  buffer_load_dwordx4 v[104:107], v10, s[8:11], s60 offen offset:128 nt
  v_dot2_f32_bf16 v48, v80, v24, v48
  v_dot2_f32_bf16 v48, v81, v25, v48
  v_dot2_f32_bf16 v48, v82, v26, v48
  v_dot2_f32_bf16 v48, v83, v27, v48
  s_waitcnt vmcnt(7)
  buffer_load_dwordx4 a[68:71], v55, s[20:23], s71 offen offset:2048 nt
  s_waitcnt vmcnt(7)
  buffer_load_dwordx4 v[108:111], v11, s[8:11], s60 offen nt
  v_dot2_f32_bf16 v48, v84, v28, v48
  v_dot2_f32_bf16 v48, v85, v29, v48
  v_dot2_f32_bf16 v48, v86, v30, v48
  v_dot2_f32_bf16 v48, v87, v31, v48
  s_nop 2
  v_add_f32_dpp v48, v48, v48 quad_perm:[1,0,3,2] row_mask:0xf bank_mask:0xf
  s_nop 1
  v_add_f32_dpp v48, v48, v48 quad_perm:[2,3,0,1] row_mask:0xf bank_mask:0xf
  s_nop 1
  v_add_f32_dpp v48, v48, v48 row_half_mirror row_mask:0xf bank_mask:0xf
  v_cvt_pk_bf16_f32 v48, v48, v48
  v_and_b32 v48, s72, v48
  v_mul_f32 v48, s66, v48
  v_cvt_pk_bf16_f32 v48, v48, v48
  v_and_b32 v245, s72, v48
  ds_write_b32 v252, v245 offset:212
  s_waitcnt vmcnt(7)
  s_and_b32 s60, s61, 0xffff
  s_mul_i32 s60, s60, 384
  buffer_load_dwordx4 v[64:67], v10, s[8:11], s60 offen nt
  v_dot2_f32_bf16 v48, v88, v20, 0
  v_dot2_f32_bf16 v48, v89, v21, v48
  v_dot2_f32_bf16 v48, v90, v22, v48
  v_dot2_f32_bf16 v48, v91, v23, v48
  s_waitcnt vmcnt(7)
  buffer_load_dwordx4 v[68:71], v10, s[8:11], s60 offen offset:128 nt
  v_dot2_f32_bf16 v48, v92, v24, v48
  v_dot2_f32_bf16 v48, v93, v25, v48
  v_dot2_f32_bf16 v48, v94, v26, v48
  v_dot2_f32_bf16 v48, v95, v27, v48
  s_waitcnt vmcnt(7)
  buffer_load_dwordx4 a[72:75], v55, s[20:23], s71 offen offset:2304 nt
  s_waitcnt vmcnt(7)
  buffer_load_dwordx4 v[72:75], v11, s[8:11], s60 offen nt
  v_dot2_f32_bf16 v48, v96, v28, v48
  v_dot2_f32_bf16 v48, v97, v29, v48
  v_dot2_f32_bf16 v48, v98, v30, v48
  v_dot2_f32_bf16 v48, v99, v31, v48
  s_nop 2
  v_add_f32_dpp v48, v48, v48 quad_perm:[1,0,3,2] row_mask:0xf bank_mask:0xf
  s_nop 1
  v_add_f32_dpp v48, v48, v48 quad_perm:[2,3,0,1] row_mask:0xf bank_mask:0xf
  s_nop 1
  v_add_f32_dpp v48, v48, v48 row_half_mirror row_mask:0xf bank_mask:0xf
  v_cvt_pk_bf16_f32 v48, v48, v48
  v_and_b32 v48, s72, v48
  v_mul_f32 v48, s66, v48
  v_cvt_pk_bf16_f32 v48, v48, v48
  v_and_b32 v246, s72, v48
  ds_write_b32 v252, v246 offset:216
  s_waitcnt vmcnt(7)
  s_lshr_b32 s60, s61, 16
  s_mul_i32 s60, s60, 384
  buffer_load_dwordx4 v[76:79], v10, s[8:11], s60 offen nt
  v_dot2_f32_bf16 v48, v100, v20, 0
  v_dot2_f32_bf16 v48, v101, v21, v48
  v_dot2_f32_bf16 v48, v102, v22, v48
  v_dot2_f32_bf16 v48, v103, v23, v48
  s_waitcnt vmcnt(7)
  v_readlane_b32 s61, v14, 28
  buffer_load_dwordx4 v[80:83], v10, s[8:11], s60 offen offset:128 nt
  v_dot2_f32_bf16 v48, v104, v24, v48
  v_dot2_f32_bf16 v48, v105, v25, v48
  v_dot2_f32_bf16 v48, v106, v26, v48
  v_dot2_f32_bf16 v48, v107, v27, v48
  s_waitcnt vmcnt(7)
  buffer_load_dwordx4 a[76:79], v55, s[20:23], s71 offen offset:2560 nt
  s_waitcnt vmcnt(7)
  buffer_load_dwordx4 v[84:87], v11, s[8:11], s60 offen nt
  v_dot2_f32_bf16 v48, v108, v28, v48
  v_dot2_f32_bf16 v48, v109, v29, v48
  v_dot2_f32_bf16 v48, v110, v30, v48
  v_dot2_f32_bf16 v48, v111, v31, v48
  s_nop 2
  v_add_f32_dpp v48, v48, v48 quad_perm:[1,0,3,2] row_mask:0xf bank_mask:0xf
  s_nop 1
  v_add_f32_dpp v48, v48, v48 quad_perm:[2,3,0,1] row_mask:0xf bank_mask:0xf
  s_nop 1
  v_add_f32_dpp v48, v48, v48 row_half_mirror row_mask:0xf bank_mask:0xf
  v_cvt_pk_bf16_f32 v48, v48, v48
  v_and_b32 v48, s72, v48
  v_mul_f32 v48, s66, v48
  v_cvt_pk_bf16_f32 v48, v48, v48
  v_and_b32 v247, s72, v48
  ds_write_b32 v252, v247 offset:220
  s_waitcnt vmcnt(7)
  s_and_b32 s60, s61, 0xffff
  s_mul_i32 s60, s60, 384
  buffer_load_dwordx4 v[88:91], v10, s[8:11], s60 offen nt
  v_dot2_f32_bf16 v48, v64, v20, 0
  v_dot2_f32_bf16 v48, v65, v21, v48
  v_dot2_f32_bf16 v48, v66, v22, v48
  v_dot2_f32_bf16 v48, v67, v23, v48
  s_waitcnt vmcnt(7)
  buffer_load_dwordx4 v[92:95], v10, s[8:11], s60 offen offset:128 nt
  v_dot2_f32_bf16 v48, v68, v24, v48
  v_dot2_f32_bf16 v48, v69, v25, v48
  v_dot2_f32_bf16 v48, v70, v26, v48
  v_dot2_f32_bf16 v48, v71, v27, v48
  s_waitcnt vmcnt(7)
  buffer_load_dwordx4 a[80:83], v55, s[20:23], s71 offen offset:2816 nt
  s_waitcnt vmcnt(7)
  buffer_load_dwordx4 v[96:99], v11, s[8:11], s60 offen nt
  v_dot2_f32_bf16 v48, v72, v28, v48
  v_dot2_f32_bf16 v48, v73, v29, v48
  v_dot2_f32_bf16 v48, v74, v30, v48
  v_dot2_f32_bf16 v48, v75, v31, v48
  s_nop 2
  v_add_f32_dpp v48, v48, v48 quad_perm:[1,0,3,2] row_mask:0xf bank_mask:0xf
  s_nop 1
  v_add_f32_dpp v48, v48, v48 quad_perm:[2,3,0,1] row_mask:0xf bank_mask:0xf
  s_nop 1
  v_add_f32_dpp v48, v48, v48 row_half_mirror row_mask:0xf bank_mask:0xf
  v_cvt_pk_bf16_f32 v48, v48, v48
  v_and_b32 v48, s72, v48
  v_mul_f32 v48, s66, v48
  v_cvt_pk_bf16_f32 v48, v48, v48
  v_and_b32 v244, s72, v48
  ds_write_b32 v252, v244 offset:224
  s_waitcnt vmcnt(7)
  s_lshr_b32 s60, s61, 16
  s_mul_i32 s60, s60, 384
  buffer_load_dwordx4 v[100:103], v10, s[8:11], s60 offen nt
  v_dot2_f32_bf16 v48, v76, v20, 0
  v_dot2_f32_bf16 v48, v77, v21, v48
  v_dot2_f32_bf16 v48, v78, v22, v48
  v_dot2_f32_bf16 v48, v79, v23, v48
  s_waitcnt vmcnt(7)
  v_readlane_b32 s61, v14, 29
  buffer_load_dwordx4 v[104:107], v10, s[8:11], s60 offen offset:128 nt
  v_dot2_f32_bf16 v48, v80, v24, v48
  v_dot2_f32_bf16 v48, v81, v25, v48
  v_dot2_f32_bf16 v48, v82, v26, v48
  v_dot2_f32_bf16 v48, v83, v27, v48
  s_waitcnt vmcnt(7)
  buffer_load_dwordx4 a[84:87], v55, s[20:23], s71 offen offset:3072 nt
  s_waitcnt vmcnt(7)
  buffer_load_dwordx4 v[108:111], v11, s[8:11], s60 offen nt
  v_dot2_f32_bf16 v48, v84, v28, v48
  v_dot2_f32_bf16 v48, v85, v29, v48
  v_dot2_f32_bf16 v48, v86, v30, v48
  v_dot2_f32_bf16 v48, v87, v31, v48
  s_nop 2
  v_add_f32_dpp v48, v48, v48 quad_perm:[1,0,3,2] row_mask:0xf bank_mask:0xf
  s_nop 1
  v_add_f32_dpp v48, v48, v48 quad_perm:[2,3,0,1] row_mask:0xf bank_mask:0xf
  s_nop 1
  v_add_f32_dpp v48, v48, v48 row_half_mirror row_mask:0xf bank_mask:0xf
  v_cvt_pk_bf16_f32 v48, v48, v48
  v_and_b32 v48, s72, v48
  v_mul_f32 v48, s66, v48
  v_cvt_pk_bf16_f32 v48, v48, v48
  v_and_b32 v245, s72, v48
  ds_write_b32 v252, v245 offset:228
  s_waitcnt vmcnt(7)
  s_and_b32 s60, s61, 0xffff
  s_mul_i32 s60, s60, 384
  buffer_load_dwordx4 v[64:67], v10, s[8:11], s60 offen nt
  v_dot2_f32_bf16 v48, v88, v20, 0
  v_dot2_f32_bf16 v48, v89, v21, v48
  v_dot2_f32_bf16 v48, v90, v22, v48
  v_dot2_f32_bf16 v48, v91, v23, v48
  s_waitcnt vmcnt(7)
  buffer_load_dwordx4 v[68:71], v10, s[8:11], s60 offen offset:128 nt
  v_dot2_f32_bf16 v48, v92, v24, v48
  v_dot2_f32_bf16 v48, v93, v25, v48
  v_dot2_f32_bf16 v48, v94, v26, v48
  v_dot2_f32_bf16 v48, v95, v27, v48
  s_waitcnt vmcnt(7)
  buffer_load_dwordx4 a[88:91], v55, s[20:23], s71 offen offset:3328 nt
  s_waitcnt vmcnt(7)
  buffer_load_dwordx4 v[72:75], v11, s[8:11], s60 offen nt
  v_dot2_f32_bf16 v48, v96, v28, v48
  v_dot2_f32_bf16 v48, v97, v29, v48
  v_dot2_f32_bf16 v48, v98, v30, v48
  v_dot2_f32_bf16 v48, v99, v31, v48
  s_nop 2
  v_add_f32_dpp v48, v48, v48 quad_perm:[1,0,3,2] row_mask:0xf bank_mask:0xf
  s_nop 1
  v_add_f32_dpp v48, v48, v48 quad_perm:[2,3,0,1] row_mask:0xf bank_mask:0xf
  s_nop 1
  v_add_f32_dpp v48, v48, v48 row_half_mirror row_mask:0xf bank_mask:0xf
  v_cvt_pk_bf16_f32 v48, v48, v48
  v_and_b32 v48, s72, v48
  v_mul_f32 v48, s66, v48
  v_cvt_pk_bf16_f32 v48, v48, v48
  v_and_b32 v246, s72, v48
  ds_write_b32 v252, v246 offset:232
  s_waitcnt vmcnt(7)
  s_lshr_b32 s60, s61, 16
  s_mul_i32 s60, s60, 384
  buffer_load_dwordx4 v[76:79], v10, s[8:11], s60 offen nt
  v_dot2_f32_bf16 v48, v100, v20, 0
  v_dot2_f32_bf16 v48, v101, v21, v48
  v_dot2_f32_bf16 v48, v102, v22, v48
  v_dot2_f32_bf16 v48, v103, v23, v48
  s_waitcnt vmcnt(7)
  v_readlane_b32 s61, v14, 30
  buffer_load_dwordx4 v[80:83], v10, s[8:11], s60 offen offset:128 nt
  v_dot2_f32_bf16 v48, v104, v24, v48
  v_dot2_f32_bf16 v48, v105, v25, v48
  v_dot2_f32_bf16 v48, v106, v26, v48
  v_dot2_f32_bf16 v48, v107, v27, v48
  s_waitcnt vmcnt(7)
  buffer_load_dwordx4 a[92:95], v55, s[20:23], s71 offen offset:3584 nt
  s_waitcnt vmcnt(7)
  buffer_load_dwordx4 v[84:87], v11, s[8:11], s60 offen nt
  v_dot2_f32_bf16 v48, v108, v28, v48
  v_dot2_f32_bf16 v48, v109, v29, v48
  v_dot2_f32_bf16 v48, v110, v30, v48
  v_dot2_f32_bf16 v48, v111, v31, v48
  s_nop 2
  v_add_f32_dpp v48, v48, v48 quad_perm:[1,0,3,2] row_mask:0xf bank_mask:0xf
  s_nop 1
  v_add_f32_dpp v48, v48, v48 quad_perm:[2,3,0,1] row_mask:0xf bank_mask:0xf
  s_nop 1
  v_add_f32_dpp v48, v48, v48 row_half_mirror row_mask:0xf bank_mask:0xf
  v_cvt_pk_bf16_f32 v48, v48, v48
  v_and_b32 v48, s72, v48
  v_mul_f32 v48, s66, v48
  v_cvt_pk_bf16_f32 v48, v48, v48
  v_and_b32 v247, s72, v48
  ds_write_b32 v252, v247 offset:236
  s_waitcnt vmcnt(7)
  s_and_b32 s60, s61, 0xffff
  s_mul_i32 s60, s60, 384
  buffer_load_dwordx4 v[88:91], v10, s[8:11], s60 offen nt
  v_dot2_f32_bf16 v48, v64, v20, 0
  v_dot2_f32_bf16 v48, v65, v21, v48
  v_dot2_f32_bf16 v48, v66, v22, v48
  v_dot2_f32_bf16 v48, v67, v23, v48
  s_waitcnt vmcnt(7)
  buffer_load_dwordx4 v[92:95], v10, s[8:11], s60 offen offset:128 nt
  v_dot2_f32_bf16 v48, v68, v24, v48
  v_dot2_f32_bf16 v48, v69, v25, v48
  v_dot2_f32_bf16 v48, v70, v26, v48
  v_dot2_f32_bf16 v48, v71, v27, v48
  s_waitcnt vmcnt(7)
  s_mov_b32 s71, 7680
  buffer_load_dwordx4 a[96:99], v55, s[20:23], s71 offen nt
  s_waitcnt vmcnt(7)
  buffer_load_dwordx4 v[96:99], v11, s[8:11], s60 offen nt
  v_dot2_f32_bf16 v48, v72, v28, v48
  v_dot2_f32_bf16 v48, v73, v29, v48
  v_dot2_f32_bf16 v48, v74, v30, v48
  v_dot2_f32_bf16 v48, v75, v31, v48
  s_nop 2
  v_add_f32_dpp v48, v48, v48 quad_perm:[1,0,3,2] row_mask:0xf bank_mask:0xf
  s_nop 1
  v_add_f32_dpp v48, v48, v48 quad_perm:[2,3,0,1] row_mask:0xf bank_mask:0xf
  s_nop 1
  v_add_f32_dpp v48, v48, v48 row_half_mirror row_mask:0xf bank_mask:0xf
  v_cvt_pk_bf16_f32 v48, v48, v48
  v_and_b32 v48, s72, v48
  v_mul_f32 v48, s66, v48
  v_cvt_pk_bf16_f32 v48, v48, v48
  v_and_b32 v244, s72, v48
  ds_write_b32 v252, v244 offset:240
  s_waitcnt vmcnt(7)
  s_lshr_b32 s60, s61, 16
  s_mul_i32 s60, s60, 384
  buffer_load_dwordx4 v[100:103], v10, s[8:11], s60 offen nt
  v_dot2_f32_bf16 v48, v76, v20, 0
  v_dot2_f32_bf16 v48, v77, v21, v48
  v_dot2_f32_bf16 v48, v78, v22, v48
  v_dot2_f32_bf16 v48, v79, v23, v48
  s_waitcnt vmcnt(7)
  v_readlane_b32 s61, v14, 31
  buffer_load_dwordx4 v[104:107], v10, s[8:11], s60 offen offset:128 nt
  v_dot2_f32_bf16 v48, v80, v24, v48
  v_dot2_f32_bf16 v48, v81, v25, v48
  v_dot2_f32_bf16 v48, v82, v26, v48
  v_dot2_f32_bf16 v48, v83, v27, v48
  s_waitcnt vmcnt(7)
  buffer_load_dwordx4 a[100:103], v55, s[20:23], s71 offen offset:256 nt
  s_waitcnt vmcnt(7)
  buffer_load_dwordx4 v[108:111], v11, s[8:11], s60 offen nt
  v_dot2_f32_bf16 v48, v84, v28, v48
  v_dot2_f32_bf16 v48, v85, v29, v48
  v_dot2_f32_bf16 v48, v86, v30, v48
  v_dot2_f32_bf16 v48, v87, v31, v48
  s_nop 2
  v_add_f32_dpp v48, v48, v48 quad_perm:[1,0,3,2] row_mask:0xf bank_mask:0xf
  s_nop 1
  v_add_f32_dpp v48, v48, v48 quad_perm:[2,3,0,1] row_mask:0xf bank_mask:0xf
  s_nop 1
  v_add_f32_dpp v48, v48, v48 row_half_mirror row_mask:0xf bank_mask:0xf
  v_cvt_pk_bf16_f32 v48, v48, v48
  v_and_b32 v48, s72, v48
  v_mul_f32 v48, s66, v48
  v_cvt_pk_bf16_f32 v48, v48, v48
  v_and_b32 v245, s72, v48
  ds_write_b32 v252, v245 offset:244
  s_waitcnt vmcnt(7)
  s_and_b32 s60, s61, 0xffff
  s_mul_i32 s60, s60, 384
  buffer_load_dwordx4 v[64:67], v10, s[8:11], s60 offen nt
  v_dot2_f32_bf16 v48, v88, v20, 0
  v_dot2_f32_bf16 v48, v89, v21, v48
  v_dot2_f32_bf16 v48, v90, v22, v48
  v_dot2_f32_bf16 v48, v91, v23, v48
  s_waitcnt vmcnt(7)
  buffer_load_dwordx4 v[68:71], v10, s[8:11], s60 offen offset:128 nt
  v_dot2_f32_bf16 v48, v92, v24, v48
  v_dot2_f32_bf16 v48, v93, v25, v48
  v_dot2_f32_bf16 v48, v94, v26, v48
  v_dot2_f32_bf16 v48, v95, v27, v48
  s_waitcnt vmcnt(7)
  buffer_load_dwordx4 a[104:107], v55, s[20:23], s71 offen offset:512 nt
  s_waitcnt vmcnt(7)
  buffer_load_dwordx4 v[72:75], v11, s[8:11], s60 offen nt
  v_dot2_f32_bf16 v48, v96, v28, v48
  v_dot2_f32_bf16 v48, v97, v29, v48
  v_dot2_f32_bf16 v48, v98, v30, v48
  v_dot2_f32_bf16 v48, v99, v31, v48
  s_nop 2
  v_add_f32_dpp v48, v48, v48 quad_perm:[1,0,3,2] row_mask:0xf bank_mask:0xf
  s_nop 1
  v_add_f32_dpp v48, v48, v48 quad_perm:[2,3,0,1] row_mask:0xf bank_mask:0xf
  s_nop 1
  v_add_f32_dpp v48, v48, v48 row_half_mirror row_mask:0xf bank_mask:0xf
  v_cvt_pk_bf16_f32 v48, v48, v48
  v_and_b32 v48, s72, v48
  v_mul_f32 v48, s66, v48
  v_cvt_pk_bf16_f32 v48, v48, v48
  v_and_b32 v246, s72, v48
  ds_write_b32 v252, v246 offset:248
  s_waitcnt vmcnt(7)
  s_lshr_b32 s60, s61, 16
  s_mul_i32 s60, s60, 384
  buffer_load_dwordx4 v[76:79], v10, s[8:11], s60 offen nt
  v_dot2_f32_bf16 v48, v100, v20, 0
  v_dot2_f32_bf16 v48, v101, v21, v48
  v_dot2_f32_bf16 v48, v102, v22, v48
  v_dot2_f32_bf16 v48, v103, v23, v48
  s_waitcnt vmcnt(7)
  v_readlane_b32 s61, v14, 32
  buffer_load_dwordx4 v[80:83], v10, s[8:11], s60 offen offset:128 nt
  v_dot2_f32_bf16 v48, v104, v24, v48
  v_dot2_f32_bf16 v48, v105, v25, v48
  v_dot2_f32_bf16 v48, v106, v26, v48
  v_dot2_f32_bf16 v48, v107, v27, v48
  s_waitcnt vmcnt(7)
  buffer_load_dwordx4 a[108:111], v55, s[20:23], s71 offen offset:768 nt
  s_waitcnt vmcnt(7)
  buffer_load_dwordx4 v[84:87], v11, s[8:11], s60 offen nt
  v_dot2_f32_bf16 v48, v108, v28, v48
  v_dot2_f32_bf16 v48, v109, v29, v48
  v_dot2_f32_bf16 v48, v110, v30, v48
  v_dot2_f32_bf16 v48, v111, v31, v48
  s_nop 2
  v_add_f32_dpp v48, v48, v48 quad_perm:[1,0,3,2] row_mask:0xf bank_mask:0xf
  s_nop 1
  v_add_f32_dpp v48, v48, v48 quad_perm:[2,3,0,1] row_mask:0xf bank_mask:0xf
  s_nop 1
  v_add_f32_dpp v48, v48, v48 row_half_mirror row_mask:0xf bank_mask:0xf
  v_cvt_pk_bf16_f32 v48, v48, v48
  v_and_b32 v48, s72, v48
  v_mul_f32 v48, s66, v48
  v_cvt_pk_bf16_f32 v48, v48, v48
  v_and_b32 v247, s72, v48
  ds_write_b32 v252, v247 offset:252
  s_waitcnt vmcnt(7)
  s_and_b32 s60, s61, 0xffff
  s_mul_i32 s60, s60, 384
  buffer_load_dwordx4 v[88:91], v10, s[8:11], s60 offen nt
  v_dot2_f32_bf16 v48, v64, v20, 0
  v_dot2_f32_bf16 v48, v65, v21, v48
  v_dot2_f32_bf16 v48, v66, v22, v48
  v_dot2_f32_bf16 v48, v67, v23, v48
  s_waitcnt vmcnt(7)
  buffer_load_dwordx4 v[92:95], v10, s[8:11], s60 offen offset:128 nt
  v_dot2_f32_bf16 v48, v68, v24, v48
  v_dot2_f32_bf16 v48, v69, v25, v48
  v_dot2_f32_bf16 v48, v70, v26, v48
  v_dot2_f32_bf16 v48, v71, v27, v48
  s_waitcnt vmcnt(7)
  buffer_load_dwordx4 a[112:115], v55, s[20:23], s71 offen offset:1024 nt
  s_waitcnt vmcnt(7)
  buffer_load_dwordx4 v[96:99], v11, s[8:11], s60 offen nt
  v_dot2_f32_bf16 v48, v72, v28, v48
  v_dot2_f32_bf16 v48, v73, v29, v48
  v_dot2_f32_bf16 v48, v74, v30, v48
  v_dot2_f32_bf16 v48, v75, v31, v48
  s_nop 2
  v_add_f32_dpp v48, v48, v48 quad_perm:[1,0,3,2] row_mask:0xf bank_mask:0xf
  s_nop 1
  v_add_f32_dpp v48, v48, v48 quad_perm:[2,3,0,1] row_mask:0xf bank_mask:0xf
  s_nop 1
  v_add_f32_dpp v48, v48, v48 row_half_mirror row_mask:0xf bank_mask:0xf
  v_cvt_pk_bf16_f32 v48, v48, v48
  v_and_b32 v48, s72, v48
  v_mul_f32 v48, s66, v48
  v_cvt_pk_bf16_f32 v48, v48, v48
  v_and_b32 v244, s72, v48
  ds_write_b32 v252, v244 offset:256
  s_waitcnt vmcnt(7)
  s_lshr_b32 s60, s61, 16
  s_mul_i32 s60, s60, 384
  buffer_load_dwordx4 v[100:103], v10, s[8:11], s60 offen nt
  v_dot2_f32_bf16 v48, v76, v20, 0
  v_dot2_f32_bf16 v48, v77, v21, v48
  v_dot2_f32_bf16 v48, v78, v22, v48
  v_dot2_f32_bf16 v48, v79, v23, v48
  s_waitcnt vmcnt(7)
  v_readlane_b32 s61, v14, 33
  buffer_load_dwordx4 v[104:107], v10, s[8:11], s60 offen offset:128 nt
  v_dot2_f32_bf16 v48, v80, v24, v48
  v_dot2_f32_bf16 v48, v81, v25, v48
  v_dot2_f32_bf16 v48, v82, v26, v48
  v_dot2_f32_bf16 v48, v83, v27, v48
  s_waitcnt vmcnt(7)
  buffer_load_dwordx4 a[116:119], v55, s[20:23], s71 offen offset:1280 nt
  s_waitcnt vmcnt(7)
  buffer_load_dwordx4 v[108:111], v11, s[8:11], s60 offen nt
  v_dot2_f32_bf16 v48, v84, v28, v48
  v_dot2_f32_bf16 v48, v85, v29, v48
  v_dot2_f32_bf16 v48, v86, v30, v48
  v_dot2_f32_bf16 v48, v87, v31, v48
  s_nop 2
  v_add_f32_dpp v48, v48, v48 quad_perm:[1,0,3,2] row_mask:0xf bank_mask:0xf
  s_nop 1
  v_add_f32_dpp v48, v48, v48 quad_perm:[2,3,0,1] row_mask:0xf bank_mask:0xf
  s_nop 1
  v_add_f32_dpp v48, v48, v48 row_half_mirror row_mask:0xf bank_mask:0xf
  v_cvt_pk_bf16_f32 v48, v48, v48
  v_and_b32 v48, s72, v48
  v_mul_f32 v48, s66, v48
  v_cvt_pk_bf16_f32 v48, v48, v48
  v_and_b32 v245, s72, v48
  ds_write_b32 v252, v245 offset:260
  s_waitcnt vmcnt(7)
  s_and_b32 s60, s61, 0xffff
  s_mul_i32 s60, s60, 384
  buffer_load_dwordx4 v[64:67], v10, s[8:11], s60 offen nt
  v_dot2_f32_bf16 v48, v88, v20, 0
  v_dot2_f32_bf16 v48, v89, v21, v48
  v_dot2_f32_bf16 v48, v90, v22, v48
  v_dot2_f32_bf16 v48, v91, v23, v48
  s_waitcnt vmcnt(7)
  buffer_load_dwordx4 v[68:71], v10, s[8:11], s60 offen offset:128 nt
  v_dot2_f32_bf16 v48, v92, v24, v48
  v_dot2_f32_bf16 v48, v93, v25, v48
  v_dot2_f32_bf16 v48, v94, v26, v48
  v_dot2_f32_bf16 v48, v95, v27, v48
  s_waitcnt vmcnt(7)
  buffer_load_dwordx4 a[120:123], v55, s[20:23], s71 offen offset:1536 nt
  s_waitcnt vmcnt(7)
  buffer_load_dwordx4 v[72:75], v11, s[8:11], s60 offen nt
  v_dot2_f32_bf16 v48, v96, v28, v48
  v_dot2_f32_bf16 v48, v97, v29, v48
  v_dot2_f32_bf16 v48, v98, v30, v48
  v_dot2_f32_bf16 v48, v99, v31, v48
  s_nop 2
  v_add_f32_dpp v48, v48, v48 quad_perm:[1,0,3,2] row_mask:0xf bank_mask:0xf
  s_nop 1
  v_add_f32_dpp v48, v48, v48 quad_perm:[2,3,0,1] row_mask:0xf bank_mask:0xf
  s_nop 1
  v_add_f32_dpp v48, v48, v48 row_half_mirror row_mask:0xf bank_mask:0xf
  v_cvt_pk_bf16_f32 v48, v48, v48
  v_and_b32 v48, s72, v48
  v_mul_f32 v48, s66, v48
  v_cvt_pk_bf16_f32 v48, v48, v48
  v_and_b32 v246, s72, v48
  ds_write_b32 v252, v246 offset:264
  s_waitcnt vmcnt(7)
  s_lshr_b32 s60, s61, 16
  s_mul_i32 s60, s60, 384
  buffer_load_dwordx4 v[76:79], v10, s[8:11], s60 offen nt
  v_dot2_f32_bf16 v48, v100, v20, 0
  v_dot2_f32_bf16 v48, v101, v21, v48
  v_dot2_f32_bf16 v48, v102, v22, v48
  v_dot2_f32_bf16 v48, v103, v23, v48
  s_waitcnt vmcnt(7)
  v_readlane_b32 s61, v14, 34
  buffer_load_dwordx4 v[80:83], v10, s[8:11], s60 offen offset:128 nt
  v_dot2_f32_bf16 v48, v104, v24, v48
  v_dot2_f32_bf16 v48, v105, v25, v48
  v_dot2_f32_bf16 v48, v106, v26, v48
  v_dot2_f32_bf16 v48, v107, v27, v48
  s_waitcnt vmcnt(7)
  buffer_load_dwordx4 a[124:127], v55, s[20:23], s71 offen offset:1792 nt
  s_waitcnt vmcnt(7)
  buffer_load_dwordx4 v[84:87], v11, s[8:11], s60 offen nt
  v_dot2_f32_bf16 v48, v108, v28, v48
  v_dot2_f32_bf16 v48, v109, v29, v48
  v_dot2_f32_bf16 v48, v110, v30, v48
  v_dot2_f32_bf16 v48, v111, v31, v48
  s_nop 2
  v_add_f32_dpp v48, v48, v48 quad_perm:[1,0,3,2] row_mask:0xf bank_mask:0xf
  s_nop 1
  v_add_f32_dpp v48, v48, v48 quad_perm:[2,3,0,1] row_mask:0xf bank_mask:0xf
  s_nop 1
  v_add_f32_dpp v48, v48, v48 row_half_mirror row_mask:0xf bank_mask:0xf
  v_cvt_pk_bf16_f32 v48, v48, v48
  v_and_b32 v48, s72, v48
  v_mul_f32 v48, s66, v48
  v_cvt_pk_bf16_f32 v48, v48, v48
  v_and_b32 v247, s72, v48
  ds_write_b32 v252, v247 offset:268
  s_waitcnt vmcnt(7)
  s_and_b32 s60, s61, 0xffff
  s_mul_i32 s60, s60, 384
  buffer_load_dwordx4 v[88:91], v10, s[8:11], s60 offen nt
  v_dot2_f32_bf16 v48, v64, v20, 0
  v_dot2_f32_bf16 v48, v65, v21, v48
  v_dot2_f32_bf16 v48, v66, v22, v48
  v_dot2_f32_bf16 v48, v67, v23, v48
  s_waitcnt vmcnt(7)
  buffer_load_dwordx4 v[92:95], v10, s[8:11], s60 offen offset:128 nt
  v_dot2_f32_bf16 v48, v68, v24, v48
  v_dot2_f32_bf16 v48, v69, v25, v48
  v_dot2_f32_bf16 v48, v70, v26, v48
  v_dot2_f32_bf16 v48, v71, v27, v48
  s_waitcnt vmcnt(7)
  buffer_load_dwordx4 a[128:131], v55, s[20:23], s71 offen offset:2048 nt
  s_waitcnt vmcnt(7)
  buffer_load_dwordx4 v[96:99], v11, s[8:11], s60 offen nt
  v_dot2_f32_bf16 v48, v72, v28, v48
  v_dot2_f32_bf16 v48, v73, v29, v48
  v_dot2_f32_bf16 v48, v74, v30, v48
  v_dot2_f32_bf16 v48, v75, v31, v48
  s_nop 2
  v_add_f32_dpp v48, v48, v48 quad_perm:[1,0,3,2] row_mask:0xf bank_mask:0xf
  s_nop 1
  v_add_f32_dpp v48, v48, v48 quad_perm:[2,3,0,1] row_mask:0xf bank_mask:0xf
  s_nop 1
  v_add_f32_dpp v48, v48, v48 row_half_mirror row_mask:0xf bank_mask:0xf
  v_cvt_pk_bf16_f32 v48, v48, v48
  v_and_b32 v48, s72, v48
  v_mul_f32 v48, s66, v48
  v_cvt_pk_bf16_f32 v48, v48, v48
  v_and_b32 v244, s72, v48
  ds_write_b32 v252, v244 offset:272
  s_waitcnt vmcnt(7)
  s_lshr_b32 s60, s61, 16
  s_mul_i32 s60, s60, 384
  buffer_load_dwordx4 v[100:103], v10, s[8:11], s60 offen nt
  v_dot2_f32_bf16 v48, v76, v20, 0
  v_dot2_f32_bf16 v48, v77, v21, v48
  v_dot2_f32_bf16 v48, v78, v22, v48
  v_dot2_f32_bf16 v48, v79, v23, v48
  s_waitcnt vmcnt(7)
  v_readlane_b32 s61, v14, 35
  buffer_load_dwordx4 v[104:107], v10, s[8:11], s60 offen offset:128 nt
  v_dot2_f32_bf16 v48, v80, v24, v48
  v_dot2_f32_bf16 v48, v81, v25, v48
  v_dot2_f32_bf16 v48, v82, v26, v48
  v_dot2_f32_bf16 v48, v83, v27, v48
  s_waitcnt vmcnt(7)
  buffer_load_dwordx4 a[132:135], v55, s[20:23], s71 offen offset:2304 nt
  s_waitcnt vmcnt(7)
  buffer_load_dwordx4 v[108:111], v11, s[8:11], s60 offen nt
  v_dot2_f32_bf16 v48, v84, v28, v48
  v_dot2_f32_bf16 v48, v85, v29, v48
  v_dot2_f32_bf16 v48, v86, v30, v48
  v_dot2_f32_bf16 v48, v87, v31, v48
  s_nop 2
  v_add_f32_dpp v48, v48, v48 quad_perm:[1,0,3,2] row_mask:0xf bank_mask:0xf
  s_nop 1
  v_add_f32_dpp v48, v48, v48 quad_perm:[2,3,0,1] row_mask:0xf bank_mask:0xf
  s_nop 1
  v_add_f32_dpp v48, v48, v48 row_half_mirror row_mask:0xf bank_mask:0xf
  v_cvt_pk_bf16_f32 v48, v48, v48
  v_and_b32 v48, s72, v48
  v_mul_f32 v48, s66, v48
  v_cvt_pk_bf16_f32 v48, v48, v48
  v_and_b32 v245, s72, v48
  ds_write_b32 v252, v245 offset:276
  s_waitcnt vmcnt(7)
  s_and_b32 s60, s61, 0xffff
  s_mul_i32 s60, s60, 384
  buffer_load_dwordx4 v[64:67], v10, s[8:11], s60 offen nt
  v_dot2_f32_bf16 v48, v88, v20, 0
  v_dot2_f32_bf16 v48, v89, v21, v48
  v_dot2_f32_bf16 v48, v90, v22, v48
  v_dot2_f32_bf16 v48, v91, v23, v48
  s_waitcnt vmcnt(7)
  buffer_load_dwordx4 v[68:71], v10, s[8:11], s60 offen offset:128 nt
  v_dot2_f32_bf16 v48, v92, v24, v48
  v_dot2_f32_bf16 v48, v93, v25, v48
  v_dot2_f32_bf16 v48, v94, v26, v48
  v_dot2_f32_bf16 v48, v95, v27, v48
  s_waitcnt vmcnt(7)
  buffer_load_dwordx4 a[136:139], v55, s[20:23], s71 offen offset:2560 nt
  s_waitcnt vmcnt(7)
  buffer_load_dwordx4 v[72:75], v11, s[8:11], s60 offen nt
  v_dot2_f32_bf16 v48, v96, v28, v48
  v_dot2_f32_bf16 v48, v97, v29, v48
  v_dot2_f32_bf16 v48, v98, v30, v48
  v_dot2_f32_bf16 v48, v99, v31, v48
  s_nop 2
  v_add_f32_dpp v48, v48, v48 quad_perm:[1,0,3,2] row_mask:0xf bank_mask:0xf
  s_nop 1
  v_add_f32_dpp v48, v48, v48 quad_perm:[2,3,0,1] row_mask:0xf bank_mask:0xf
  s_nop 1
  v_add_f32_dpp v48, v48, v48 row_half_mirror row_mask:0xf bank_mask:0xf
  v_cvt_pk_bf16_f32 v48, v48, v48
  v_and_b32 v48, s72, v48
  v_mul_f32 v48, s66, v48
  v_cvt_pk_bf16_f32 v48, v48, v48
  v_and_b32 v246, s72, v48
  ds_write_b32 v252, v246 offset:280
  s_waitcnt vmcnt(7)
  s_lshr_b32 s60, s61, 16
  s_mul_i32 s60, s60, 384
  buffer_load_dwordx4 v[76:79], v10, s[8:11], s60 offen nt
  v_dot2_f32_bf16 v48, v100, v20, 0
  v_dot2_f32_bf16 v48, v101, v21, v48
  v_dot2_f32_bf16 v48, v102, v22, v48
  v_dot2_f32_bf16 v48, v103, v23, v48
  s_waitcnt vmcnt(7)
  v_readlane_b32 s61, v14, 36
  buffer_load_dwordx4 v[80:83], v10, s[8:11], s60 offen offset:128 nt
  v_dot2_f32_bf16 v48, v104, v24, v48
  v_dot2_f32_bf16 v48, v105, v25, v48
  v_dot2_f32_bf16 v48, v106, v26, v48
  v_dot2_f32_bf16 v48, v107, v27, v48
  s_waitcnt vmcnt(7)
  buffer_load_dwordx4 a[140:143], v55, s[20:23], s71 offen offset:2816 nt
  s_waitcnt vmcnt(7)
  buffer_load_dwordx4 v[84:87], v11, s[8:11], s60 offen nt
  v_dot2_f32_bf16 v48, v108, v28, v48
  v_dot2_f32_bf16 v48, v109, v29, v48
  v_dot2_f32_bf16 v48, v110, v30, v48
  v_dot2_f32_bf16 v48, v111, v31, v48
  s_nop 2
  v_add_f32_dpp v48, v48, v48 quad_perm:[1,0,3,2] row_mask:0xf bank_mask:0xf
  s_nop 1
  v_add_f32_dpp v48, v48, v48 quad_perm:[2,3,0,1] row_mask:0xf bank_mask:0xf
  s_nop 1
  v_add_f32_dpp v48, v48, v48 row_half_mirror row_mask:0xf bank_mask:0xf
  v_cvt_pk_bf16_f32 v48, v48, v48
  v_and_b32 v48, s72, v48
  v_mul_f32 v48, s66, v48
  v_cvt_pk_bf16_f32 v48, v48, v48
  v_and_b32 v247, s72, v48
  ds_write_b32 v252, v247 offset:284
  s_waitcnt vmcnt(7)
  s_and_b32 s60, s61, 0xffff
  s_mul_i32 s60, s60, 384
  buffer_load_dwordx4 v[88:91], v10, s[8:11], s60 offen nt
  v_dot2_f32_bf16 v48, v64, v20, 0
  v_dot2_f32_bf16 v48, v65, v21, v48
  v_dot2_f32_bf16 v48, v66, v22, v48
  v_dot2_f32_bf16 v48, v67, v23, v48
  s_waitcnt vmcnt(7)
  buffer_load_dwordx4 v[92:95], v10, s[8:11], s60 offen offset:128 nt
  v_dot2_f32_bf16 v48, v68, v24, v48
  v_dot2_f32_bf16 v48, v69, v25, v48
  v_dot2_f32_bf16 v48, v70, v26, v48
  v_dot2_f32_bf16 v48, v71, v27, v48
  s_waitcnt vmcnt(7)
  buffer_load_dwordx4 a[144:147], v55, s[20:23], s71 offen offset:3072 nt
  s_waitcnt vmcnt(7)
  buffer_load_dwordx4 v[96:99], v11, s[8:11], s60 offen nt
  v_dot2_f32_bf16 v48, v72, v28, v48
  v_dot2_f32_bf16 v48, v73, v29, v48
  v_dot2_f32_bf16 v48, v74, v30, v48
  v_dot2_f32_bf16 v48, v75, v31, v48
  s_nop 2
  v_add_f32_dpp v48, v48, v48 quad_perm:[1,0,3,2] row_mask:0xf bank_mask:0xf
  s_nop 1
  v_add_f32_dpp v48, v48, v48 quad_perm:[2,3,0,1] row_mask:0xf bank_mask:0xf
  s_nop 1
  v_add_f32_dpp v48, v48, v48 row_half_mirror row_mask:0xf bank_mask:0xf
  v_cvt_pk_bf16_f32 v48, v48, v48
  v_and_b32 v48, s72, v48
  v_mul_f32 v48, s66, v48
  v_cvt_pk_bf16_f32 v48, v48, v48
  v_and_b32 v244, s72, v48
  ds_write_b32 v252, v244 offset:288
  s_waitcnt vmcnt(7)
  s_lshr_b32 s60, s61, 16
  s_mul_i32 s60, s60, 384
  buffer_load_dwordx4 v[100:103], v10, s[8:11], s60 offen nt
  v_dot2_f32_bf16 v48, v76, v20, 0
  v_dot2_f32_bf16 v48, v77, v21, v48
  v_dot2_f32_bf16 v48, v78, v22, v48
  v_dot2_f32_bf16 v48, v79, v23, v48
  s_waitcnt vmcnt(7)
  v_readlane_b32 s61, v14, 37
  buffer_load_dwordx4 v[104:107], v10, s[8:11], s60 offen offset:128 nt
  v_dot2_f32_bf16 v48, v80, v24, v48
  v_dot2_f32_bf16 v48, v81, v25, v48
  v_dot2_f32_bf16 v48, v82, v26, v48
  v_dot2_f32_bf16 v48, v83, v27, v48
  s_waitcnt vmcnt(7)
  buffer_load_dwordx4 a[148:151], v55, s[20:23], s71 offen offset:3328 nt
  s_waitcnt vmcnt(7)
  buffer_load_dwordx4 v[108:111], v11, s[8:11], s60 offen nt
  v_dot2_f32_bf16 v48, v84, v28, v48
  v_dot2_f32_bf16 v48, v85, v29, v48
  v_dot2_f32_bf16 v48, v86, v30, v48
  v_dot2_f32_bf16 v48, v87, v31, v48
  s_nop 2
  v_add_f32_dpp v48, v48, v48 quad_perm:[1,0,3,2] row_mask:0xf bank_mask:0xf
  s_nop 1
  v_add_f32_dpp v48, v48, v48 quad_perm:[2,3,0,1] row_mask:0xf bank_mask:0xf
  s_nop 1
  v_add_f32_dpp v48, v48, v48 row_half_mirror row_mask:0xf bank_mask:0xf
  v_cvt_pk_bf16_f32 v48, v48, v48
  v_and_b32 v48, s72, v48
  v_mul_f32 v48, s66, v48
  v_cvt_pk_bf16_f32 v48, v48, v48
  v_and_b32 v245, s72, v48
  ds_write_b32 v252, v245 offset:292
  s_waitcnt vmcnt(7)
  s_and_b32 s60, s61, 0xffff
  s_mul_i32 s60, s60, 384
  buffer_load_dwordx4 v[64:67], v10, s[8:11], s60 offen nt
  v_dot2_f32_bf16 v48, v88, v20, 0
  v_dot2_f32_bf16 v48, v89, v21, v48
  v_dot2_f32_bf16 v48, v90, v22, v48
  v_dot2_f32_bf16 v48, v91, v23, v48
  s_waitcnt vmcnt(7)
  buffer_load_dwordx4 v[68:71], v10, s[8:11], s60 offen offset:128 nt
  v_dot2_f32_bf16 v48, v92, v24, v48
  v_dot2_f32_bf16 v48, v93, v25, v48
  v_dot2_f32_bf16 v48, v94, v26, v48
  v_dot2_f32_bf16 v48, v95, v27, v48
  s_waitcnt vmcnt(7)
  buffer_load_dwordx4 a[152:155], v55, s[20:23], s71 offen offset:3584 nt
  s_waitcnt vmcnt(7)
  buffer_load_dwordx4 v[72:75], v11, s[8:11], s60 offen nt
  v_dot2_f32_bf16 v48, v96, v28, v48
  v_dot2_f32_bf16 v48, v97, v29, v48
  v_dot2_f32_bf16 v48, v98, v30, v48
  v_dot2_f32_bf16 v48, v99, v31, v48
  s_nop 2
  v_add_f32_dpp v48, v48, v48 quad_perm:[1,0,3,2] row_mask:0xf bank_mask:0xf
  s_nop 1
  v_add_f32_dpp v48, v48, v48 quad_perm:[2,3,0,1] row_mask:0xf bank_mask:0xf
  s_nop 1
  v_add_f32_dpp v48, v48, v48 row_half_mirror row_mask:0xf bank_mask:0xf
  v_cvt_pk_bf16_f32 v48, v48, v48
  v_and_b32 v48, s72, v48
  v_mul_f32 v48, s66, v48
  v_cvt_pk_bf16_f32 v48, v48, v48
  v_and_b32 v246, s72, v48
  ds_write_b32 v252, v246 offset:296
  s_waitcnt vmcnt(7)
  s_lshr_b32 s60, s61, 16
  s_mul_i32 s60, s60, 384
  buffer_load_dwordx4 v[76:79], v10, s[8:11], s60 offen nt
  v_dot2_f32_bf16 v48, v100, v20, 0
  v_dot2_f32_bf16 v48, v101, v21, v48
  v_dot2_f32_bf16 v48, v102, v22, v48
  v_dot2_f32_bf16 v48, v103, v23, v48
  s_waitcnt vmcnt(7)
  v_readlane_b32 s61, v14, 38
  buffer_load_dwordx4 v[80:83], v10, s[8:11], s60 offen offset:128 nt
  v_dot2_f32_bf16 v48, v104, v24, v48
  v_dot2_f32_bf16 v48, v105, v25, v48
  v_dot2_f32_bf16 v48, v106, v26, v48
  v_dot2_f32_bf16 v48, v107, v27, v48
  s_waitcnt vmcnt(7)
  s_mov_b32 s71, 11520
  buffer_load_dwordx4 a[156:159], v55, s[20:23], s71 offen nt
  s_waitcnt vmcnt(7)
  buffer_load_dwordx4 v[84:87], v11, s[8:11], s60 offen nt
  v_dot2_f32_bf16 v48, v108, v28, v48
  v_dot2_f32_bf16 v48, v109, v29, v48
  v_dot2_f32_bf16 v48, v110, v30, v48
  v_dot2_f32_bf16 v48, v111, v31, v48
  s_nop 2
  v_add_f32_dpp v48, v48, v48 quad_perm:[1,0,3,2] row_mask:0xf bank_mask:0xf
  s_nop 1
  v_add_f32_dpp v48, v48, v48 quad_perm:[2,3,0,1] row_mask:0xf bank_mask:0xf
  s_nop 1
  v_add_f32_dpp v48, v48, v48 row_half_mirror row_mask:0xf bank_mask:0xf
  v_cvt_pk_bf16_f32 v48, v48, v48
  v_and_b32 v48, s72, v48
  v_mul_f32 v48, s66, v48
  v_cvt_pk_bf16_f32 v48, v48, v48
  v_and_b32 v247, s72, v48
  ds_write_b32 v252, v247 offset:300
  s_waitcnt vmcnt(7)
  s_and_b32 s60, s61, 0xffff
  s_mul_i32 s60, s60, 384
  buffer_load_dwordx4 v[88:91], v10, s[8:11], s60 offen nt
  v_dot2_f32_bf16 v48, v64, v20, 0
  v_dot2_f32_bf16 v48, v65, v21, v48
  v_dot2_f32_bf16 v48, v66, v22, v48
  v_dot2_f32_bf16 v48, v67, v23, v48
  s_waitcnt vmcnt(7)
  buffer_load_dwordx4 v[92:95], v10, s[8:11], s60 offen offset:128 nt
  v_dot2_f32_bf16 v48, v68, v24, v48
  v_dot2_f32_bf16 v48, v69, v25, v48
  v_dot2_f32_bf16 v48, v70, v26, v48
  v_dot2_f32_bf16 v48, v71, v27, v48
  s_waitcnt vmcnt(7)
  buffer_load_dwordx4 a[160:163], v55, s[20:23], s71 offen offset:256 nt
  s_waitcnt vmcnt(7)
  buffer_load_dwordx4 v[96:99], v11, s[8:11], s60 offen nt
  v_dot2_f32_bf16 v48, v72, v28, v48
  v_dot2_f32_bf16 v48, v73, v29, v48
  v_dot2_f32_bf16 v48, v74, v30, v48
  v_dot2_f32_bf16 v48, v75, v31, v48
  s_nop 2
  v_add_f32_dpp v48, v48, v48 quad_perm:[1,0,3,2] row_mask:0xf bank_mask:0xf
  s_nop 1
  v_add_f32_dpp v48, v48, v48 quad_perm:[2,3,0,1] row_mask:0xf bank_mask:0xf
  s_nop 1
  v_add_f32_dpp v48, v48, v48 row_half_mirror row_mask:0xf bank_mask:0xf
  v_cvt_pk_bf16_f32 v48, v48, v48
  v_and_b32 v48, s72, v48
  v_mul_f32 v48, s66, v48
  v_cvt_pk_bf16_f32 v48, v48, v48
  v_and_b32 v244, s72, v48
  ds_write_b32 v252, v244 offset:304
  s_waitcnt vmcnt(7)
  s_lshr_b32 s60, s61, 16
  s_mul_i32 s60, s60, 384
  buffer_load_dwordx4 v[100:103], v10, s[8:11], s60 offen nt
  v_dot2_f32_bf16 v48, v76, v20, 0
  v_dot2_f32_bf16 v48, v77, v21, v48
  v_dot2_f32_bf16 v48, v78, v22, v48
  v_dot2_f32_bf16 v48, v79, v23, v48
  s_waitcnt vmcnt(7)
  v_readlane_b32 s61, v14, 39
  buffer_load_dwordx4 v[104:107], v10, s[8:11], s60 offen offset:128 nt
  v_dot2_f32_bf16 v48, v80, v24, v48
  v_dot2_f32_bf16 v48, v81, v25, v48
  v_dot2_f32_bf16 v48, v82, v26, v48
  v_dot2_f32_bf16 v48, v83, v27, v48
  s_waitcnt vmcnt(7)
  buffer_load_dwordx4 a[164:167], v55, s[20:23], s71 offen offset:512 nt
  s_waitcnt vmcnt(7)
  buffer_load_dwordx4 v[108:111], v11, s[8:11], s60 offen nt
  v_dot2_f32_bf16 v48, v84, v28, v48
  v_dot2_f32_bf16 v48, v85, v29, v48
  v_dot2_f32_bf16 v48, v86, v30, v48
  v_dot2_f32_bf16 v48, v87, v31, v48
  s_nop 2
  v_add_f32_dpp v48, v48, v48 quad_perm:[1,0,3,2] row_mask:0xf bank_mask:0xf
  s_nop 1
  v_add_f32_dpp v48, v48, v48 quad_perm:[2,3,0,1] row_mask:0xf bank_mask:0xf
  s_nop 1
  v_add_f32_dpp v48, v48, v48 row_half_mirror row_mask:0xf bank_mask:0xf
  v_cvt_pk_bf16_f32 v48, v48, v48
  v_and_b32 v48, s72, v48
  v_mul_f32 v48, s66, v48
  v_cvt_pk_bf16_f32 v48, v48, v48
  v_and_b32 v245, s72, v48
  ds_write_b32 v252, v245 offset:308
  s_waitcnt vmcnt(7)
  s_and_b32 s60, s61, 0xffff
  s_mul_i32 s60, s60, 384
  buffer_load_dwordx4 v[64:67], v10, s[8:11], s60 offen nt
  v_dot2_f32_bf16 v48, v88, v20, 0
  v_dot2_f32_bf16 v48, v89, v21, v48
  v_dot2_f32_bf16 v48, v90, v22, v48
  v_dot2_f32_bf16 v48, v91, v23, v48
  s_waitcnt vmcnt(7)
  buffer_load_dwordx4 v[68:71], v10, s[8:11], s60 offen offset:128 nt
  v_dot2_f32_bf16 v48, v92, v24, v48
  v_dot2_f32_bf16 v48, v93, v25, v48
  v_dot2_f32_bf16 v48, v94, v26, v48
  v_dot2_f32_bf16 v48, v95, v27, v48
  s_waitcnt vmcnt(7)
  buffer_load_dwordx4 a[168:171], v55, s[20:23], s71 offen offset:768 nt
  s_waitcnt vmcnt(7)
  buffer_load_dwordx4 v[72:75], v11, s[8:11], s60 offen nt
  v_dot2_f32_bf16 v48, v96, v28, v48
  v_dot2_f32_bf16 v48, v97, v29, v48
  v_dot2_f32_bf16 v48, v98, v30, v48
  v_dot2_f32_bf16 v48, v99, v31, v48
  s_nop 2
  v_add_f32_dpp v48, v48, v48 quad_perm:[1,0,3,2] row_mask:0xf bank_mask:0xf
  s_nop 1
  v_add_f32_dpp v48, v48, v48 quad_perm:[2,3,0,1] row_mask:0xf bank_mask:0xf
  s_nop 1
  v_add_f32_dpp v48, v48, v48 row_half_mirror row_mask:0xf bank_mask:0xf
  v_cvt_pk_bf16_f32 v48, v48, v48
  v_and_b32 v48, s72, v48
  v_mul_f32 v48, s66, v48
  v_cvt_pk_bf16_f32 v48, v48, v48
  v_and_b32 v246, s72, v48
  ds_write_b32 v252, v246 offset:312
  s_waitcnt vmcnt(7)
  s_lshr_b32 s60, s61, 16
  s_mul_i32 s60, s60, 384
  buffer_load_dwordx4 v[76:79], v10, s[8:11], s60 offen nt
  v_dot2_f32_bf16 v48, v100, v20, 0
  v_dot2_f32_bf16 v48, v101, v21, v48
  v_dot2_f32_bf16 v48, v102, v22, v48
  v_dot2_f32_bf16 v48, v103, v23, v48
  s_waitcnt vmcnt(7)
  v_readlane_b32 s61, v14, 40
  buffer_load_dwordx4 v[80:83], v10, s[8:11], s60 offen offset:128 nt
  v_dot2_f32_bf16 v48, v104, v24, v48
  v_dot2_f32_bf16 v48, v105, v25, v48
  v_dot2_f32_bf16 v48, v106, v26, v48
  v_dot2_f32_bf16 v48, v107, v27, v48
  s_waitcnt vmcnt(7)
  buffer_load_dwordx4 a[172:175], v55, s[20:23], s71 offen offset:1024 nt
  s_waitcnt vmcnt(7)
  buffer_load_dwordx4 v[84:87], v11, s[8:11], s60 offen nt
  v_dot2_f32_bf16 v48, v108, v28, v48
  v_dot2_f32_bf16 v48, v109, v29, v48
  v_dot2_f32_bf16 v48, v110, v30, v48
  v_dot2_f32_bf16 v48, v111, v31, v48
  s_nop 2
  v_add_f32_dpp v48, v48, v48 quad_perm:[1,0,3,2] row_mask:0xf bank_mask:0xf
  s_nop 1
  v_add_f32_dpp v48, v48, v48 quad_perm:[2,3,0,1] row_mask:0xf bank_mask:0xf
  s_nop 1
  v_add_f32_dpp v48, v48, v48 row_half_mirror row_mask:0xf bank_mask:0xf
  v_cvt_pk_bf16_f32 v48, v48, v48
  v_and_b32 v48, s72, v48
  v_mul_f32 v48, s66, v48
  v_cvt_pk_bf16_f32 v48, v48, v48
  v_and_b32 v247, s72, v48
  ds_write_b32 v252, v247 offset:316
  s_waitcnt vmcnt(7)
  s_and_b32 s60, s61, 0xffff
  s_mul_i32 s60, s60, 384
  buffer_load_dwordx4 v[88:91], v10, s[8:11], s60 offen nt
  v_dot2_f32_bf16 v48, v64, v20, 0
  v_dot2_f32_bf16 v48, v65, v21, v48
  v_dot2_f32_bf16 v48, v66, v22, v48
  v_dot2_f32_bf16 v48, v67, v23, v48
  s_waitcnt vmcnt(7)
  buffer_load_dwordx4 v[92:95], v10, s[8:11], s60 offen offset:128 nt
  v_dot2_f32_bf16 v48, v68, v24, v48
  v_dot2_f32_bf16 v48, v69, v25, v48
  v_dot2_f32_bf16 v48, v70, v26, v48
  v_dot2_f32_bf16 v48, v71, v27, v48
  s_waitcnt vmcnt(7)
  buffer_load_dwordx4 a[176:179], v55, s[20:23], s71 offen offset:1280 nt
  s_waitcnt vmcnt(7)
  buffer_load_dwordx4 v[96:99], v11, s[8:11], s60 offen nt
  v_dot2_f32_bf16 v48, v72, v28, v48
  v_dot2_f32_bf16 v48, v73, v29, v48
  v_dot2_f32_bf16 v48, v74, v30, v48
  v_dot2_f32_bf16 v48, v75, v31, v48
  s_nop 2
  v_add_f32_dpp v48, v48, v48 quad_perm:[1,0,3,2] row_mask:0xf bank_mask:0xf
  s_nop 1
  v_add_f32_dpp v48, v48, v48 quad_perm:[2,3,0,1] row_mask:0xf bank_mask:0xf
  s_nop 1
  v_add_f32_dpp v48, v48, v48 row_half_mirror row_mask:0xf bank_mask:0xf
  v_cvt_pk_bf16_f32 v48, v48, v48
  v_and_b32 v48, s72, v48
  v_mul_f32 v48, s66, v48
  v_cvt_pk_bf16_f32 v48, v48, v48
  v_and_b32 v244, s72, v48
  ds_write_b32 v252, v244 offset:320
  s_waitcnt vmcnt(7)
  s_lshr_b32 s60, s61, 16
  s_mul_i32 s60, s60, 384
  buffer_load_dwordx4 v[100:103], v10, s[8:11], s60 offen nt
  v_dot2_f32_bf16 v48, v76, v20, 0
  v_dot2_f32_bf16 v48, v77, v21, v48
  v_dot2_f32_bf16 v48, v78, v22, v48
  v_dot2_f32_bf16 v48, v79, v23, v48
  s_waitcnt vmcnt(7)
  v_readlane_b32 s61, v14, 41
  buffer_load_dwordx4 v[104:107], v10, s[8:11], s60 offen offset:128 nt
  v_dot2_f32_bf16 v48, v80, v24, v48
  v_dot2_f32_bf16 v48, v81, v25, v48
  v_dot2_f32_bf16 v48, v82, v26, v48
  v_dot2_f32_bf16 v48, v83, v27, v48
  s_waitcnt vmcnt(7)
  buffer_load_dwordx4 a[180:183], v55, s[20:23], s71 offen offset:1536 nt
  s_waitcnt vmcnt(7)
  buffer_load_dwordx4 v[108:111], v11, s[8:11], s60 offen nt
  v_dot2_f32_bf16 v48, v84, v28, v48
  v_dot2_f32_bf16 v48, v85, v29, v48
  v_dot2_f32_bf16 v48, v86, v30, v48
  v_dot2_f32_bf16 v48, v87, v31, v48
  s_nop 2
  v_add_f32_dpp v48, v48, v48 quad_perm:[1,0,3,2] row_mask:0xf bank_mask:0xf
  s_nop 1
  v_add_f32_dpp v48, v48, v48 quad_perm:[2,3,0,1] row_mask:0xf bank_mask:0xf
  s_nop 1
  v_add_f32_dpp v48, v48, v48 row_half_mirror row_mask:0xf bank_mask:0xf
  v_cvt_pk_bf16_f32 v48, v48, v48
  v_and_b32 v48, s72, v48
  v_mul_f32 v48, s66, v48
  v_cvt_pk_bf16_f32 v48, v48, v48
  v_and_b32 v245, s72, v48
  ds_write_b32 v252, v245 offset:324
  s_waitcnt vmcnt(7)
  s_and_b32 s60, s61, 0xffff
  s_mul_i32 s60, s60, 384
  buffer_load_dwordx4 v[64:67], v10, s[8:11], s60 offen nt
  v_dot2_f32_bf16 v48, v88, v20, 0
  v_dot2_f32_bf16 v48, v89, v21, v48
  v_dot2_f32_bf16 v48, v90, v22, v48
  v_dot2_f32_bf16 v48, v91, v23, v48
  s_waitcnt vmcnt(7)
  buffer_load_dwordx4 v[68:71], v10, s[8:11], s60 offen offset:128 nt
  v_dot2_f32_bf16 v48, v92, v24, v48
  v_dot2_f32_bf16 v48, v93, v25, v48
  v_dot2_f32_bf16 v48, v94, v26, v48
  v_dot2_f32_bf16 v48, v95, v27, v48
  s_waitcnt vmcnt(7)
  buffer_load_dwordx4 a[184:187], v55, s[20:23], s71 offen offset:1792 nt
  s_waitcnt vmcnt(7)
  buffer_load_dwordx4 v[72:75], v11, s[8:11], s60 offen nt
  v_dot2_f32_bf16 v48, v96, v28, v48
  v_dot2_f32_bf16 v48, v97, v29, v48
  v_dot2_f32_bf16 v48, v98, v30, v48
  v_dot2_f32_bf16 v48, v99, v31, v48
  s_nop 2
  v_add_f32_dpp v48, v48, v48 quad_perm:[1,0,3,2] row_mask:0xf bank_mask:0xf
  s_nop 1
  v_add_f32_dpp v48, v48, v48 quad_perm:[2,3,0,1] row_mask:0xf bank_mask:0xf
  s_nop 1
  v_add_f32_dpp v48, v48, v48 row_half_mirror row_mask:0xf bank_mask:0xf
  v_cvt_pk_bf16_f32 v48, v48, v48
  v_and_b32 v48, s72, v48
  v_mul_f32 v48, s66, v48
  v_cvt_pk_bf16_f32 v48, v48, v48
  v_and_b32 v246, s72, v48
  ds_write_b32 v252, v246 offset:328
  s_waitcnt vmcnt(7)
  s_lshr_b32 s60, s61, 16
  s_mul_i32 s60, s60, 384
  buffer_load_dwordx4 v[76:79], v10, s[8:11], s60 offen nt
  v_dot2_f32_bf16 v48, v100, v20, 0
  v_dot2_f32_bf16 v48, v101, v21, v48
  v_dot2_f32_bf16 v48, v102, v22, v48
  v_dot2_f32_bf16 v48, v103, v23, v48
  s_waitcnt vmcnt(7)
  v_readlane_b32 s61, v14, 42
  buffer_load_dwordx4 v[80:83], v10, s[8:11], s60 offen offset:128 nt
  v_dot2_f32_bf16 v48, v104, v24, v48
  v_dot2_f32_bf16 v48, v105, v25, v48
  v_dot2_f32_bf16 v48, v106, v26, v48
  v_dot2_f32_bf16 v48, v107, v27, v48
  s_waitcnt vmcnt(7)
  buffer_load_dwordx4 a[188:191], v55, s[20:23], s71 offen offset:2048 nt
  s_waitcnt vmcnt(7)
  buffer_load_dwordx4 v[84:87], v11, s[8:11], s60 offen nt
  v_dot2_f32_bf16 v48, v108, v28, v48
  v_dot2_f32_bf16 v48, v109, v29, v48
  v_dot2_f32_bf16 v48, v110, v30, v48
  v_dot2_f32_bf16 v48, v111, v31, v48
  s_nop 2
  v_add_f32_dpp v48, v48, v48 quad_perm:[1,0,3,2] row_mask:0xf bank_mask:0xf
  s_nop 1
  v_add_f32_dpp v48, v48, v48 quad_perm:[2,3,0,1] row_mask:0xf bank_mask:0xf
  s_nop 1
  v_add_f32_dpp v48, v48, v48 row_half_mirror row_mask:0xf bank_mask:0xf
  v_cvt_pk_bf16_f32 v48, v48, v48
  v_and_b32 v48, s72, v48
  v_mul_f32 v48, s66, v48
  v_cvt_pk_bf16_f32 v48, v48, v48
  v_and_b32 v247, s72, v48
  ds_write_b32 v252, v247 offset:332
  s_waitcnt vmcnt(7)
  s_and_b32 s60, s61, 0xffff
  s_mul_i32 s60, s60, 384
  buffer_load_dwordx4 v[88:91], v10, s[8:11], s60 offen nt
  v_dot2_f32_bf16 v48, v64, v20, 0
  v_dot2_f32_bf16 v48, v65, v21, v48
  v_dot2_f32_bf16 v48, v66, v22, v48
  v_dot2_f32_bf16 v48, v67, v23, v48
  s_waitcnt vmcnt(7)
  buffer_load_dwordx4 v[92:95], v10, s[8:11], s60 offen offset:128 nt
  v_dot2_f32_bf16 v48, v68, v24, v48
  v_dot2_f32_bf16 v48, v69, v25, v48
  v_dot2_f32_bf16 v48, v70, v26, v48
  v_dot2_f32_bf16 v48, v71, v27, v48
  s_waitcnt vmcnt(7)
  buffer_load_dwordx4 a[192:195], v55, s[20:23], s71 offen offset:2304 nt
  s_waitcnt vmcnt(7)
  buffer_load_dwordx4 v[96:99], v11, s[8:11], s60 offen nt
  v_dot2_f32_bf16 v48, v72, v28, v48
  v_dot2_f32_bf16 v48, v73, v29, v48
  v_dot2_f32_bf16 v48, v74, v30, v48
  v_dot2_f32_bf16 v48, v75, v31, v48
  s_nop 2
  v_add_f32_dpp v48, v48, v48 quad_perm:[1,0,3,2] row_mask:0xf bank_mask:0xf
  s_nop 1
  v_add_f32_dpp v48, v48, v48 quad_perm:[2,3,0,1] row_mask:0xf bank_mask:0xf
  s_nop 1
  v_add_f32_dpp v48, v48, v48 row_half_mirror row_mask:0xf bank_mask:0xf
  v_cvt_pk_bf16_f32 v48, v48, v48
  v_and_b32 v48, s72, v48
  v_mul_f32 v48, s66, v48
  v_cvt_pk_bf16_f32 v48, v48, v48
  v_and_b32 v244, s72, v48
  ds_write_b32 v252, v244 offset:336
  s_waitcnt vmcnt(7)
  s_lshr_b32 s60, s61, 16
  s_mul_i32 s60, s60, 384
  buffer_load_dwordx4 v[100:103], v10, s[8:11], s60 offen nt
  v_dot2_f32_bf16 v48, v76, v20, 0
  v_dot2_f32_bf16 v48, v77, v21, v48
  v_dot2_f32_bf16 v48, v78, v22, v48
  v_dot2_f32_bf16 v48, v79, v23, v48
  s_waitcnt vmcnt(7)
  v_readlane_b32 s61, v14, 43
  buffer_load_dwordx4 v[104:107], v10, s[8:11], s60 offen offset:128 nt
  v_dot2_f32_bf16 v48, v80, v24, v48
  v_dot2_f32_bf16 v48, v81, v25, v48
  v_dot2_f32_bf16 v48, v82, v26, v48
  v_dot2_f32_bf16 v48, v83, v27, v48
  s_waitcnt vmcnt(7)
  buffer_load_dwordx4 a[196:199], v55, s[20:23], s71 offen offset:2560 nt
  s_waitcnt vmcnt(7)
  buffer_load_dwordx4 v[108:111], v11, s[8:11], s60 offen nt
  v_dot2_f32_bf16 v48, v84, v28, v48
  v_dot2_f32_bf16 v48, v85, v29, v48
  v_dot2_f32_bf16 v48, v86, v30, v48
  v_dot2_f32_bf16 v48, v87, v31, v48
  s_nop 2
  v_add_f32_dpp v48, v48, v48 quad_perm:[1,0,3,2] row_mask:0xf bank_mask:0xf
  s_nop 1
  v_add_f32_dpp v48, v48, v48 quad_perm:[2,3,0,1] row_mask:0xf bank_mask:0xf
  s_nop 1
  v_add_f32_dpp v48, v48, v48 row_half_mirror row_mask:0xf bank_mask:0xf
  v_cvt_pk_bf16_f32 v48, v48, v48
  v_and_b32 v48, s72, v48
  v_mul_f32 v48, s66, v48
  v_cvt_pk_bf16_f32 v48, v48, v48
  v_and_b32 v245, s72, v48
  ds_write_b32 v252, v245 offset:340
  s_waitcnt vmcnt(7)
  s_and_b32 s60, s61, 0xffff
  s_mul_i32 s60, s60, 384
  buffer_load_dwordx4 v[64:67], v10, s[8:11], s60 offen nt
  v_dot2_f32_bf16 v48, v88, v20, 0
  v_dot2_f32_bf16 v48, v89, v21, v48
  v_dot2_f32_bf16 v48, v90, v22, v48
  v_dot2_f32_bf16 v48, v91, v23, v48
  s_waitcnt vmcnt(7)
  buffer_load_dwordx4 v[68:71], v10, s[8:11], s60 offen offset:128 nt
  v_dot2_f32_bf16 v48, v92, v24, v48
  v_dot2_f32_bf16 v48, v93, v25, v48
  v_dot2_f32_bf16 v48, v94, v26, v48
  v_dot2_f32_bf16 v48, v95, v27, v48
  s_waitcnt vmcnt(7)
  buffer_load_dwordx4 a[200:203], v55, s[20:23], s71 offen offset:2816 nt
  s_waitcnt vmcnt(7)
  buffer_load_dwordx4 v[72:75], v11, s[8:11], s60 offen nt
  v_dot2_f32_bf16 v48, v96, v28, v48
  v_dot2_f32_bf16 v48, v97, v29, v48
  v_dot2_f32_bf16 v48, v98, v30, v48
  v_dot2_f32_bf16 v48, v99, v31, v48
  s_nop 2
  v_add_f32_dpp v48, v48, v48 quad_perm:[1,0,3,2] row_mask:0xf bank_mask:0xf
  s_nop 1
  v_add_f32_dpp v48, v48, v48 quad_perm:[2,3,0,1] row_mask:0xf bank_mask:0xf
  s_nop 1
  v_add_f32_dpp v48, v48, v48 row_half_mirror row_mask:0xf bank_mask:0xf
  v_cvt_pk_bf16_f32 v48, v48, v48
  v_and_b32 v48, s72, v48
  v_mul_f32 v48, s66, v48
  v_cvt_pk_bf16_f32 v48, v48, v48
  v_and_b32 v246, s72, v48
  ds_write_b32 v252, v246 offset:344
  s_waitcnt vmcnt(7)
  s_lshr_b32 s60, s61, 16
  s_mul_i32 s60, s60, 384
  buffer_load_dwordx4 v[76:79], v10, s[8:11], s60 offen nt
  v_dot2_f32_bf16 v48, v100, v20, 0
  v_dot2_f32_bf16 v48, v101, v21, v48
  v_dot2_f32_bf16 v48, v102, v22, v48
  v_dot2_f32_bf16 v48, v103, v23, v48
  s_waitcnt vmcnt(7)
  v_readlane_b32 s61, v14, 44
  buffer_load_dwordx4 v[80:83], v10, s[8:11], s60 offen offset:128 nt
  v_dot2_f32_bf16 v48, v104, v24, v48
  v_dot2_f32_bf16 v48, v105, v25, v48
  v_dot2_f32_bf16 v48, v106, v26, v48
  v_dot2_f32_bf16 v48, v107, v27, v48
  s_waitcnt vmcnt(7)
  buffer_load_dwordx4 a[204:207], v55, s[20:23], s71 offen offset:3072 nt
  s_waitcnt vmcnt(7)
  buffer_load_dwordx4 v[84:87], v11, s[8:11], s60 offen nt
  v_dot2_f32_bf16 v48, v108, v28, v48
  v_dot2_f32_bf16 v48, v109, v29, v48
  v_dot2_f32_bf16 v48, v110, v30, v48
  v_dot2_f32_bf16 v48, v111, v31, v48
  s_nop 2
  v_add_f32_dpp v48, v48, v48 quad_perm:[1,0,3,2] row_mask:0xf bank_mask:0xf
  s_nop 1
  v_add_f32_dpp v48, v48, v48 quad_perm:[2,3,0,1] row_mask:0xf bank_mask:0xf
  s_nop 1
  v_add_f32_dpp v48, v48, v48 row_half_mirror row_mask:0xf bank_mask:0xf
  v_cvt_pk_bf16_f32 v48, v48, v48
  v_and_b32 v48, s72, v48
  v_mul_f32 v48, s66, v48
  v_cvt_pk_bf16_f32 v48, v48, v48
  v_and_b32 v247, s72, v48
  ds_write_b32 v252, v247 offset:348
  s_waitcnt vmcnt(7)
  s_and_b32 s60, s61, 0xffff
  s_mul_i32 s60, s60, 384
  buffer_load_dwordx4 v[88:91], v10, s[8:11], s60 offen nt
  v_dot2_f32_bf16 v48, v64, v20, 0
  v_dot2_f32_bf16 v48, v65, v21, v48
  v_dot2_f32_bf16 v48, v66, v22, v48
  v_dot2_f32_bf16 v48, v67, v23, v48
  s_waitcnt vmcnt(7)
  buffer_load_dwordx4 v[92:95], v10, s[8:11], s60 offen offset:128 nt
  v_dot2_f32_bf16 v48, v68, v24, v48
  v_dot2_f32_bf16 v48, v69, v25, v48
  v_dot2_f32_bf16 v48, v70, v26, v48
  v_dot2_f32_bf16 v48, v71, v27, v48
  s_waitcnt vmcnt(7)
  buffer_load_dwordx4 a[208:211], v55, s[20:23], s71 offen offset:3328 nt
  s_waitcnt vmcnt(7)
  buffer_load_dwordx4 v[96:99], v11, s[8:11], s60 offen nt
  v_dot2_f32_bf16 v48, v72, v28, v48
  v_dot2_f32_bf16 v48, v73, v29, v48
  v_dot2_f32_bf16 v48, v74, v30, v48
  v_dot2_f32_bf16 v48, v75, v31, v48
  s_nop 2
  v_add_f32_dpp v48, v48, v48 quad_perm:[1,0,3,2] row_mask:0xf bank_mask:0xf
  s_nop 1
  v_add_f32_dpp v48, v48, v48 quad_perm:[2,3,0,1] row_mask:0xf bank_mask:0xf
  s_nop 1
  v_add_f32_dpp v48, v48, v48 row_half_mirror row_mask:0xf bank_mask:0xf
  v_cvt_pk_bf16_f32 v48, v48, v48
  v_and_b32 v48, s72, v48
  v_mul_f32 v48, s66, v48
  v_cvt_pk_bf16_f32 v48, v48, v48
  v_and_b32 v244, s72, v48
  ds_write_b32 v252, v244 offset:352
  s_waitcnt vmcnt(7)
  s_lshr_b32 s60, s61, 16
  s_mul_i32 s60, s60, 384
  buffer_load_dwordx4 v[100:103], v10, s[8:11], s60 offen nt
  v_dot2_f32_bf16 v48, v76, v20, 0
  v_dot2_f32_bf16 v48, v77, v21, v48
  v_dot2_f32_bf16 v48, v78, v22, v48
  v_dot2_f32_bf16 v48, v79, v23, v48
  s_waitcnt vmcnt(7)
  v_readlane_b32 s61, v14, 45
  buffer_load_dwordx4 v[104:107], v10, s[8:11], s60 offen offset:128 nt
  v_dot2_f32_bf16 v48, v80, v24, v48
  v_dot2_f32_bf16 v48, v81, v25, v48
  v_dot2_f32_bf16 v48, v82, v26, v48
  v_dot2_f32_bf16 v48, v83, v27, v48
  s_waitcnt vmcnt(7)
  buffer_load_dwordx4 a[212:215], v55, s[20:23], s71 offen offset:3584 nt
  s_waitcnt vmcnt(5)
  buffer_load_dwordx4 v[108:111], v11, s[8:11], s60 offen nt
  v_dot2_f32_bf16 v48, v84, v28, v48
  v_dot2_f32_bf16 v48, v85, v29, v48
  v_dot2_f32_bf16 v48, v86, v30, v48
  v_dot2_f32_bf16 v48, v87, v31, v48
  s_nop 2
  v_add_f32_dpp v48, v48, v48 quad_perm:[1,0,3,2] row_mask:0xf bank_mask:0xf
  s_nop 1
  v_add_f32_dpp v48, v48, v48 quad_perm:[2,3,0,1] row_mask:0xf bank_mask:0xf
  s_nop 1
  v_add_f32_dpp v48, v48, v48 row_half_mirror row_mask:0xf bank_mask:0xf
  v_cvt_pk_bf16_f32 v48, v48, v48
  v_and_b32 v48, s72, v48
  v_mul_f32 v48, s66, v48
  v_cvt_pk_bf16_f32 v48, v48, v48
  v_and_b32 v245, s72, v48
  ds_write_b32 v252, v245 offset:356
  s_waitcnt vmcnt(5)
  s_and_b32 s60, s61, 0xffff
  s_mul_i32 s60, s60, 384
  buffer_load_dwordx4 v[64:67], v10, s[8:11], s60 offen nt
  v_dot2_f32_bf16 v48, v88, v20, 0
  v_dot2_f32_bf16 v48, v89, v21, v48
  v_dot2_f32_bf16 v48, v90, v22, v48
  v_dot2_f32_bf16 v48, v91, v23, v48
  s_waitcnt vmcnt(5)
  buffer_load_dwordx4 v[68:71], v10, s[8:11], s60 offen offset:128 nt
  v_dot2_f32_bf16 v48, v92, v24, v48
  v_dot2_f32_bf16 v48, v93, v25, v48
  v_dot2_f32_bf16 v48, v94, v26, v48
  v_dot2_f32_bf16 v48, v95, v27, v48
  s_waitcnt vmcnt(5)
  buffer_load_dwordx4 v[72:75], v11, s[8:11], s60 offen nt
  s_waitcnt vmcnt(5)
  s_lshr_b32 s60, s61, 16
  s_mul_i32 s60, s60, 384
  buffer_load_dwordx4 v[76:79], v10, s[8:11], s60 offen nt
  v_dot2_f32_bf16 v48, v96, v28, v48
  v_dot2_f32_bf16 v48, v97, v29, v48
  v_dot2_f32_bf16 v48, v98, v30, v48
  v_dot2_f32_bf16 v48, v99, v31, v48
  s_nop 2
  v_add_f32_dpp v48, v48, v48 quad_perm:[1,0,3,2] row_mask:0xf bank_mask:0xf
  s_nop 1
  v_add_f32_dpp v48, v48, v48 quad_perm:[2,3,0,1] row_mask:0xf bank_mask:0xf
  s_nop 1
  v_add_f32_dpp v48, v48, v48 row_half_mirror row_mask:0xf bank_mask:0xf
  v_cvt_pk_bf16_f32 v48, v48, v48
  v_and_b32 v48, s72, v48
  v_mul_f32 v48, s66, v48
  v_cvt_pk_bf16_f32 v48, v48, v48
  v_and_b32 v246, s72, v48
  ds_write_b32 v252, v246 offset:360
  s_waitcnt vmcnt(5)
  v_readlane_b32 s61, v14, 46
  buffer_load_dwordx4 v[80:83], v10, s[8:11], s60 offen offset:128 nt
  v_dot2_f32_bf16 v48, v100, v20, 0
  v_dot2_f32_bf16 v48, v101, v21, v48
  v_dot2_f32_bf16 v48, v102, v22, v48
  v_dot2_f32_bf16 v48, v103, v23, v48
  s_waitcnt vmcnt(5)
  buffer_load_dwordx4 v[84:87], v11, s[8:11], s60 offen nt
  v_dot2_f32_bf16 v48, v104, v24, v48
  v_dot2_f32_bf16 v48, v105, v25, v48
  v_dot2_f32_bf16 v48, v106, v26, v48
  v_dot2_f32_bf16 v48, v107, v27, v48
  s_waitcnt vmcnt(5)
  s_and_b32 s60, s61, 0xffff
  s_mul_i32 s60, s60, 384
  buffer_load_dwordx4 v[88:91], v10, s[8:11], s60 offen nt
  s_waitcnt vmcnt(5)
  buffer_load_dwordx4 v[92:95], v10, s[8:11], s60 offen offset:128 nt
  v_dot2_f32_bf16 v48, v108, v28, v48
  v_dot2_f32_bf16 v48, v109, v29, v48
  v_dot2_f32_bf16 v48, v110, v30, v48
  v_dot2_f32_bf16 v48, v111, v31, v48
  s_nop 2
  v_add_f32_dpp v48, v48, v48 quad_perm:[1,0,3,2] row_mask:0xf bank_mask:0xf
  s_nop 1
  v_add_f32_dpp v48, v48, v48 quad_perm:[2,3,0,1] row_mask:0xf bank_mask:0xf
  s_nop 1
  v_add_f32_dpp v48, v48, v48 row_half_mirror row_mask:0xf bank_mask:0xf
  v_cvt_pk_bf16_f32 v48, v48, v48
  v_and_b32 v48, s72, v48
  v_mul_f32 v48, s66, v48
  v_cvt_pk_bf16_f32 v48, v48, v48
  v_and_b32 v247, s72, v48
  ds_write_b32 v252, v247 offset:364
  s_mov_b32 s62, 47
  v_add_u32 v253, 352, v252
  s_mov_b32 s78, 0
  v_mov_b32 v58, s79
  v_mov_b32 v59, s79
  v_mov_b32 v63, 4
  s_cmp_eq_u32 s56, 0
  s_cmov_b32 s40, 0x400010
  s_cmov_b32 s41, 0x2
  s_cmp_eq_u32 s56, 1
  s_cmov_b32 s40, 0x4000100
  s_cmov_b32 s41, 0x8
  s_cmp_eq_u32 s56, 2
  s_cmov_b32 s40, 0x20002000
  s_cmov_b32 s41, 0x0
  s_cmp_eq_u32 s56, 3
  s_cmov_b32 s40, 0x80040000
  s_cmov_b32 s41, 0x0
  s_lshl_b64 s[42:43], s[40:41], 1
  v_cmp_eq_u32 vcc, 0, v0
  s_nop 1
  v_cndmask_b32 v15, 0, 32, vcc
  v_mov_b32 v62, -80
  v_lshlrev_b32 v57, 2, v0
L_dispk:
  s_waitcnt lgkmcnt(0)
  v_readfirstlane_b32 s73, v58
  s_bitcmp1_b64 s[40:41], s78
  s_cbranch_scc1 L_dutyk
  s_bitcmp1_b64 s[42:43], s78
  s_cbranch_scc1 L_prock
L_selk:
  v_readfirstlane_b32 s69, v62
  s_mul_i32 s70, s78, 128
  s_sub_i32 s69, s69, s70
  s_add_i32 s73, s73, s69
  s_add_i32 s73, s73, 80
  s_ashr_i32 s73, s73, 6
  s_max_i32 s73, s73, 0
  s_min_i32 s73, s73, 6
  s_cmp_eq_u32 s73, 1
  s_cbranch_scc1 L_k1
  s_cmp_eq_u32 s73, 2
  s_cbranch_scc1 L_k2
  s_cmp_eq_u32 s73, 3
  s_cbranch_scc1 L_k3
  s_cmp_eq_u32 s73, 4
  s_cbranch_scc1 L_k4
  s_cmp_eq_u32 s73, 5
  s_cbranch_scc1 L_k5
  s_cmp_eq_u32 s73, 6
  s_cbranch_scc1 L_k6
L_k0:
  s_waitcnt vmcnt(3)
  buffer_load_dwordx4 v[96:99], v11, s[8:11], s60 offen nt
  ds_write_b128 v253, v[244:247]
  v_add_u32 v253, 16, v253
  v_dot2_f32_bf16 v48, v64, v20, 0
  v_dot2_f32_bf16 v48, v65, v21, v48
  v_dot2_f32_bf16 v48, v66, v22, v48
  v_dot2_f32_bf16 v48, v67, v23, v48
  s_waitcnt vmcnt(4)
  s_lshr_b32 s60, s61, 16
  s_mul_i32 s60, s60, 384
  buffer_load_dwordx4 v[100:103], v10, s[8:11], s60 offen nt
  v_dot2_f32_bf16 v48, v68, v24, v48
  v_dot2_f32_bf16 v48, v69, v25, v48
  v_dot2_f32_bf16 v48, v70, v26, v48
  v_dot2_f32_bf16 v48, v71, v27, v48
  s_waitcnt vmcnt(3)
  v_readlane_b32 s61, v14, s62
  s_add_u32 s62, s62, 1
  buffer_load_dwordx4 v[104:107], v10, s[8:11], s60 offen offset:128 nt
  v_dot2_f32_bf16 v48, v72, v28, v48
  v_dot2_f32_bf16 v48, v73, v29, v48
  v_dot2_f32_bf16 v48, v74, v30, v48
  v_dot2_f32_bf16 v48, v75, v31, v48
  s_nop 2
  v_add_f32_dpp v48, v48, v48 quad_perm:[1,0,3,2] row_mask:0xf bank_mask:0xf
  s_nop 1
  v_add_f32_dpp v48, v48, v48 quad_perm:[2,3,0,1] row_mask:0xf bank_mask:0xf
  s_nop 1
  v_add_f32_dpp v48, v48, v48 row_half_mirror row_mask:0xf bank_mask:0xf
  v_cvt_pk_bf16_f32 v48, v48, v48
  v_and_b32 v48, s72, v48
  v_mul_f32 v48, s66, v48
  v_cvt_pk_bf16_f32 v48, v48, v48
  v_and_b32 v244, s72, v48
  s_waitcnt vmcnt(4)
  buffer_load_dwordx4 v[108:111], v11, s[8:11], s60 offen nt
  v_dot2_f32_bf16 v48, v76, v20, 0
  v_dot2_f32_bf16 v48, v77, v21, v48
  v_dot2_f32_bf16 v48, v78, v22, v48
  v_dot2_f32_bf16 v48, v79, v23, v48
  s_waitcnt vmcnt(3)
  s_and_b32 s60, s61, 0xffff
  s_mul_i32 s60, s60, 384
  buffer_load_dwordx4 v[64:67], v10, s[8:11], s60 offen nt
  v_dot2_f32_bf16 v48, v80, v24, v48
  v_dot2_f32_bf16 v48, v81, v25, v48
  v_dot2_f32_bf16 v48, v82, v26, v48
  v_dot2_f32_bf16 v48, v83, v27, v48
  s_waitcnt vmcnt(4)
  buffer_load_dwordx4 v[68:71], v10, s[8:11], s60 offen offset:128 nt
  v_dot2_f32_bf16 v48, v84, v28, v48
  v_dot2_f32_bf16 v48, v85, v29, v48
  v_dot2_f32_bf16 v48, v86, v30, v48
  v_dot2_f32_bf16 v48, v87, v31, v48
  s_nop 2
  v_add_f32_dpp v48, v48, v48 quad_perm:[1,0,3,2] row_mask:0xf bank_mask:0xf
  s_nop 1
  v_add_f32_dpp v48, v48, v48 quad_perm:[2,3,0,1] row_mask:0xf bank_mask:0xf
  s_nop 1
  v_add_f32_dpp v48, v48, v48 row_half_mirror row_mask:0xf bank_mask:0xf
  v_cvt_pk_bf16_f32 v48, v48, v48
  v_and_b32 v48, s72, v48
  v_mul_f32 v48, s66, v48
  v_cvt_pk_bf16_f32 v48, v48, v48
  v_and_b32 v245, s72, v48
  s_waitcnt vmcnt(3)
  buffer_load_dwordx4 v[72:75], v11, s[8:11], s60 offen nt
  v_dot2_f32_bf16 v48, v88, v20, 0
  v_dot2_f32_bf16 v48, v89, v21, v48
  v_dot2_f32_bf16 v48, v90, v22, v48
  v_dot2_f32_bf16 v48, v91, v23, v48
  s_waitcnt vmcnt(4)
  s_lshr_b32 s60, s61, 16
  s_mul_i32 s60, s60, 384
  buffer_load_dwordx4 v[76:79], v10, s[8:11], s60 offen nt
  v_dot2_f32_bf16 v48, v92, v24, v48
  v_dot2_f32_bf16 v48, v93, v25, v48
  v_dot2_f32_bf16 v48, v94, v26, v48
  v_dot2_f32_bf16 v48, v95, v27, v48
  s_waitcnt vmcnt(3)
  v_readlane_b32 s61, v14, s62
  s_add_u32 s62, s62, 1
  buffer_load_dwordx4 v[80:83], v10, s[8:11], s60 offen offset:128 nt
  v_dot2_f32_bf16 v48, v96, v28, v48
  v_dot2_f32_bf16 v48, v97, v29, v48
  v_dot2_f32_bf16 v48, v98, v30, v48
  v_dot2_f32_bf16 v48, v99, v31, v48
  s_nop 2
  v_add_f32_dpp v48, v48, v48 quad_perm:[1,0,3,2] row_mask:0xf bank_mask:0xf
  s_nop 1
  v_add_f32_dpp v48, v48, v48 quad_perm:[2,3,0,1] row_mask:0xf bank_mask:0xf
  s_nop 1
  v_add_f32_dpp v48, v48, v48 row_half_mirror row_mask:0xf bank_mask:0xf
  v_cvt_pk_bf16_f32 v48, v48, v48
  v_and_b32 v48, s72, v48
  v_mul_f32 v48, s66, v48
  v_cvt_pk_bf16_f32 v48, v48, v48
  v_and_b32 v246, s72, v48
  s_waitcnt vmcnt(4)
  buffer_load_dwordx4 v[84:87], v11, s[8:11], s60 offen nt
  v_dot2_f32_bf16 v48, v100, v20, 0
  v_dot2_f32_bf16 v48, v101, v21, v48
  v_dot2_f32_bf16 v48, v102, v22, v48
  v_dot2_f32_bf16 v48, v103, v23, v48
  ds_read_b64 v[58:59], v5 offset:13896
  ds_add_rtn_u32 v62, v57, v15 offset:13904
  s_waitcnt vmcnt(3)
  s_and_b32 s60, s61, 0xffff
  s_mul_i32 s60, s60, 384
  buffer_load_dwordx4 v[88:91], v10, s[8:11], s60 offen nt
  v_dot2_f32_bf16 v48, v104, v24, v48
  v_dot2_f32_bf16 v48, v105, v25, v48
  v_dot2_f32_bf16 v48, v106, v26, v48
  v_dot2_f32_bf16 v48, v107, v27, v48
  s_waitcnt vmcnt(4)
  buffer_load_dwordx4 v[92:95], v10, s[8:11], s60 offen offset:128 nt
  v_dot2_f32_bf16 v48, v108, v28, v48
  v_dot2_f32_bf16 v48, v109, v29, v48
  v_dot2_f32_bf16 v48, v110, v30, v48
  v_dot2_f32_bf16 v48, v111, v31, v48
  s_nop 2
  v_add_f32_dpp v48, v48, v48 quad_perm:[1,0,3,2] row_mask:0xf bank_mask:0xf
  s_nop 1
  v_add_f32_dpp v48, v48, v48 quad_perm:[2,3,0,1] row_mask:0xf bank_mask:0xf
  s_nop 1
  v_add_f32_dpp v48, v48, v48 row_half_mirror row_mask:0xf bank_mask:0xf
  v_cvt_pk_bf16_f32 v48, v48, v48
  v_and_b32 v48, s72, v48
  v_mul_f32 v48, s66, v48
  v_cvt_pk_bf16_f32 v48, v48, v48
  v_and_b32 v247, s72, v48
  s_add_u32 s78, s78, 1
  s_cmp_lt_u32 s78, 8
  s_cbranch_scc1 L_dispk
  s_branch L_tailk
L_k1:
  s_waitcnt vmcnt(4)
  buffer_load_dwordx4 v[96:99], v11, s[8:11], s60 offen nt
  ds_write_b128 v253, v[244:247]
  v_add_u32 v253, 16, v253
  v_dot2_f32_bf16 v48, v64, v20, 0
  v_dot2_f32_bf16 v48, v65, v21, v48
  v_dot2_f32_bf16 v48, v66, v22, v48
  v_dot2_f32_bf16 v48, v67, v23, v48
  s_waitcnt vmcnt(4)
  s_lshr_b32 s60, s61, 16
  s_mul_i32 s60, s60, 384
  buffer_load_dwordx4 v[100:103], v10, s[8:11], s60 offen nt
  v_dot2_f32_bf16 v48, v68, v24, v48
  v_dot2_f32_bf16 v48, v69, v25, v48
  v_dot2_f32_bf16 v48, v70, v26, v48
  v_dot2_f32_bf16 v48, v71, v27, v48
  s_waitcnt vmcnt(4)
  v_readlane_b32 s61, v14, s62
  s_add_u32 s62, s62, 1
  buffer_load_dwordx4 v[104:107], v10, s[8:11], s60 offen offset:128 nt
  v_dot2_f32_bf16 v48, v72, v28, v48
  v_dot2_f32_bf16 v48, v73, v29, v48
  v_dot2_f32_bf16 v48, v74, v30, v48
  v_dot2_f32_bf16 v48, v75, v31, v48
  s_nop 2
  v_add_f32_dpp v48, v48, v48 quad_perm:[1,0,3,2] row_mask:0xf bank_mask:0xf
  s_nop 1
  v_add_f32_dpp v48, v48, v48 quad_perm:[2,3,0,1] row_mask:0xf bank_mask:0xf
  s_nop 1
  v_add_f32_dpp v48, v48, v48 row_half_mirror row_mask:0xf bank_mask:0xf
  v_cvt_pk_bf16_f32 v48, v48, v48
  v_and_b32 v48, s72, v48
  v_mul_f32 v48, s66, v48
  v_cvt_pk_bf16_f32 v48, v48, v48
  v_and_b32 v244, s72, v48
  s_waitcnt vmcnt(4)
  buffer_load_dwordx4 v[108:111], v11, s[8:11], s60 offen nt
  v_dot2_f32_bf16 v48, v76, v20, 0
  v_dot2_f32_bf16 v48, v77, v21, v48
  v_dot2_f32_bf16 v48, v78, v22, v48
  v_dot2_f32_bf16 v48, v79, v23, v48
  s_waitcnt vmcnt(4)
  s_and_b32 s60, s61, 0xffff
  s_mul_i32 s60, s60, 384
  buffer_load_dwordx4 v[64:67], v10, s[8:11], s60 offen nt
  v_dot2_f32_bf16 v48, v80, v24, v48
  v_dot2_f32_bf16 v48, v81, v25, v48
  v_dot2_f32_bf16 v48, v82, v26, v48
  v_dot2_f32_bf16 v48, v83, v27, v48
  s_waitcnt vmcnt(4)
  buffer_load_dwordx4 v[68:71], v10, s[8:11], s60 offen offset:128 nt
  v_dot2_f32_bf16 v48, v84, v28, v48
  v_dot2_f32_bf16 v48, v85, v29, v48
  v_dot2_f32_bf16 v48, v86, v30, v48
  v_dot2_f32_bf16 v48, v87, v31, v48
  s_nop 2
  v_add_f32_dpp v48, v48, v48 quad_perm:[1,0,3,2] row_mask:0xf bank_mask:0xf
  s_nop 1
  v_add_f32_dpp v48, v48, v48 quad_perm:[2,3,0,1] row_mask:0xf bank_mask:0xf
  s_nop 1
  v_add_f32_dpp v48, v48, v48 row_half_mirror row_mask:0xf bank_mask:0xf
  v_cvt_pk_bf16_f32 v48, v48, v48
  v_and_b32 v48, s72, v48
  v_mul_f32 v48, s66, v48
  v_cvt_pk_bf16_f32 v48, v48, v48
  v_and_b32 v245, s72, v48
  s_waitcnt vmcnt(4)
  buffer_load_dwordx4 v[72:75], v11, s[8:11], s60 offen nt
  v_dot2_f32_bf16 v48, v88, v20, 0
  v_dot2_f32_bf16 v48, v89, v21, v48
  v_dot2_f32_bf16 v48, v90, v22, v48
  v_dot2_f32_bf16 v48, v91, v23, v48
  s_waitcnt vmcnt(4)
  s_lshr_b32 s60, s61, 16
  s_mul_i32 s60, s60, 384
  buffer_load_dwordx4 v[76:79], v10, s[8:11], s60 offen nt
  v_dot2_f32_bf16 v48, v92, v24, v48
  v_dot2_f32_bf16 v48, v93, v25, v48
  v_dot2_f32_bf16 v48, v94, v26, v48
  v_dot2_f32_bf16 v48, v95, v27, v48
  s_waitcnt vmcnt(4)
  v_readlane_b32 s61, v14, s62
  s_add_u32 s62, s62, 1
  buffer_load_dwordx4 v[80:83], v10, s[8:11], s60 offen offset:128 nt
  v_dot2_f32_bf16 v48, v96, v28, v48
  v_dot2_f32_bf16 v48, v97, v29, v48
  v_dot2_f32_bf16 v48, v98, v30, v48
  v_dot2_f32_bf16 v48, v99, v31, v48
  s_nop 2
  v_add_f32_dpp v48, v48, v48 quad_perm:[1,0,3,2] row_mask:0xf bank_mask:0xf
  s_nop 1
  v_add_f32_dpp v48, v48, v48 quad_perm:[2,3,0,1] row_mask:0xf bank_mask:0xf
  s_nop 1
  v_add_f32_dpp v48, v48, v48 row_half_mirror row_mask:0xf bank_mask:0xf
  v_cvt_pk_bf16_f32 v48, v48, v48
  v_and_b32 v48, s72, v48
  v_mul_f32 v48, s66, v48
  v_cvt_pk_bf16_f32 v48, v48, v48
  v_and_b32 v246, s72, v48
  s_waitcnt vmcnt(4)
  buffer_load_dwordx4 v[84:87], v11, s[8:11], s60 offen nt
  v_dot2_f32_bf16 v48, v100, v20, 0
  v_dot2_f32_bf16 v48, v101, v21, v48
  v_dot2_f32_bf16 v48, v102, v22, v48
  v_dot2_f32_bf16 v48, v103, v23, v48
  ds_read_b64 v[58:59], v5 offset:13896
  ds_add_rtn_u32 v62, v57, v15 offset:13904
  s_waitcnt vmcnt(4)
  s_and_b32 s60, s61, 0xffff
  s_mul_i32 s60, s60, 384
  buffer_load_dwordx4 v[88:91], v10, s[8:11], s60 offen nt
  v_dot2_f32_bf16 v48, v104, v24, v48
  v_dot2_f32_bf16 v48, v105, v25, v48
  v_dot2_f32_bf16 v48, v106, v26, v48
  v_dot2_f32_bf16 v48, v107, v27, v48
  s_waitcnt vmcnt(4)
  buffer_load_dwordx4 v[92:95], v10, s[8:11], s60 offen offset:128 nt
  v_dot2_f32_bf16 v48, v108, v28, v48
  v_dot2_f32_bf16 v48, v109, v29, v48
  v_dot2_f32_bf16 v48, v110, v30, v48
  v_dot2_f32_bf16 v48, v111, v31, v48
  s_nop 2
  v_add_f32_dpp v48, v48, v48 quad_perm:[1,0,3,2] row_mask:0xf bank_mask:0xf
  s_nop 1
  v_add_f32_dpp v48, v48, v48 quad_perm:[2,3,0,1] row_mask:0xf bank_mask:0xf
  s_nop 1
  v_add_f32_dpp v48, v48, v48 row_half_mirror row_mask:0xf bank_mask:0xf
  v_cvt_pk_bf16_f32 v48, v48, v48
  v_and_b32 v48, s72, v48
  v_mul_f32 v48, s66, v48
  v_cvt_pk_bf16_f32 v48, v48, v48
  v_and_b32 v247, s72, v48
  s_add_u32 s78, s78, 1
  s_cmp_lt_u32 s78, 8
  s_cbranch_scc1 L_dispk
  s_branch L_tailk
L_k2:
  s_waitcnt vmcnt(4)
  buffer_load_dwordx4 v[96:99], v11, s[8:11], s60 offen nt
  ds_write_b128 v253, v[244:247]
  v_add_u32 v253, 16, v253
  v_dot2_f32_bf16 v48, v64, v20, 0
  v_dot2_f32_bf16 v48, v65, v21, v48
  v_dot2_f32_bf16 v48, v66, v22, v48
  v_dot2_f32_bf16 v48, v67, v23, v48
  s_waitcnt vmcnt(5)
  s_lshr_b32 s60, s61, 16
  s_mul_i32 s60, s60, 384
  buffer_load_dwordx4 v[100:103], v10, s[8:11], s60 offen nt
  v_dot2_f32_bf16 v48, v68, v24, v48
  v_dot2_f32_bf16 v48, v69, v25, v48
  v_dot2_f32_bf16 v48, v70, v26, v48
  v_dot2_f32_bf16 v48, v71, v27, v48
  s_waitcnt vmcnt(4)
  v_readlane_b32 s61, v14, s62
  s_add_u32 s62, s62, 1
  buffer_load_dwordx4 v[104:107], v10, s[8:11], s60 offen offset:128 nt
  v_dot2_f32_bf16 v48, v72, v28, v48
  v_dot2_f32_bf16 v48, v73, v29, v48
  v_dot2_f32_bf16 v48, v74, v30, v48
  v_dot2_f32_bf16 v48, v75, v31, v48
  s_nop 2
  v_add_f32_dpp v48, v48, v48 quad_perm:[1,0,3,2] row_mask:0xf bank_mask:0xf
  s_nop 1
  v_add_f32_dpp v48, v48, v48 quad_perm:[2,3,0,1] row_mask:0xf bank_mask:0xf
  s_nop 1
  v_add_f32_dpp v48, v48, v48 row_half_mirror row_mask:0xf bank_mask:0xf
  v_cvt_pk_bf16_f32 v48, v48, v48
  v_and_b32 v48, s72, v48
  v_mul_f32 v48, s66, v48
  v_cvt_pk_bf16_f32 v48, v48, v48
  v_and_b32 v244, s72, v48
  s_waitcnt vmcnt(5)
  buffer_load_dwordx4 v[108:111], v11, s[8:11], s60 offen nt
  v_dot2_f32_bf16 v48, v76, v20, 0
  v_dot2_f32_bf16 v48, v77, v21, v48
  v_dot2_f32_bf16 v48, v78, v22, v48
  v_dot2_f32_bf16 v48, v79, v23, v48
  s_waitcnt vmcnt(4)
  s_and_b32 s60, s61, 0xffff
  s_mul_i32 s60, s60, 384
  buffer_load_dwordx4 v[64:67], v10, s[8:11], s60 offen nt
  v_dot2_f32_bf16 v48, v80, v24, v48
  v_dot2_f32_bf16 v48, v81, v25, v48
  v_dot2_f32_bf16 v48, v82, v26, v48
  v_dot2_f32_bf16 v48, v83, v27, v48
  s_waitcnt vmcnt(5)
  buffer_load_dwordx4 v[68:71], v10, s[8:11], s60 offen offset:128 nt
  v_dot2_f32_bf16 v48, v84, v28, v48
  v_dot2_f32_bf16 v48, v85, v29, v48
  v_dot2_f32_bf16 v48, v86, v30, v48
  v_dot2_f32_bf16 v48, v87, v31, v48
  s_nop 2
  v_add_f32_dpp v48, v48, v48 quad_perm:[1,0,3,2] row_mask:0xf bank_mask:0xf
  s_nop 1
  v_add_f32_dpp v48, v48, v48 quad_perm:[2,3,0,1] row_mask:0xf bank_mask:0xf
  s_nop 1
  v_add_f32_dpp v48, v48, v48 row_half_mirror row_mask:0xf bank_mask:0xf
  v_cvt_pk_bf16_f32 v48, v48, v48
  v_and_b32 v48, s72, v48
  v_mul_f32 v48, s66, v48
  v_cvt_pk_bf16_f32 v48, v48, v48
  v_and_b32 v245, s72, v48
  s_waitcnt vmcnt(4)
  buffer_load_dwordx4 v[72:75], v11, s[8:11], s60 offen nt
  v_dot2_f32_bf16 v48, v88, v20, 0
  v_dot2_f32_bf16 v48, v89, v21, v48
  v_dot2_f32_bf16 v48, v90, v22, v48
  v_dot2_f32_bf16 v48, v91, v23, v48
  s_waitcnt vmcnt(5)
  s_lshr_b32 s60, s61, 16
  s_mul_i32 s60, s60, 384
  buffer_load_dwordx4 v[76:79], v10, s[8:11], s60 offen nt
  v_dot2_f32_bf16 v48, v92, v24, v48
  v_dot2_f32_bf16 v48, v93, v25, v48
  v_dot2_f32_bf16 v48, v94, v26, v48
  v_dot2_f32_bf16 v48, v95, v27, v48
  s_waitcnt vmcnt(4)
  v_readlane_b32 s61, v14, s62
  s_add_u32 s62, s62, 1
  buffer_load_dwordx4 v[80:83], v10, s[8:11], s60 offen offset:128 nt
  v_dot2_f32_bf16 v48, v96, v28, v48
  v_dot2_f32_bf16 v48, v97, v29, v48
  v_dot2_f32_bf16 v48, v98, v30, v48
  v_dot2_f32_bf16 v48, v99, v31, v48
  s_nop 2
  v_add_f32_dpp v48, v48, v48 quad_perm:[1,0,3,2] row_mask:0xf bank_mask:0xf
  s_nop 1
  v_add_f32_dpp v48, v48, v48 quad_perm:[2,3,0,1] row_mask:0xf bank_mask:0xf
  s_nop 1
  v_add_f32_dpp v48, v48, v48 row_half_mirror row_mask:0xf bank_mask:0xf
  v_cvt_pk_bf16_f32 v48, v48, v48
  v_and_b32 v48, s72, v48
  v_mul_f32 v48, s66, v48
  v_cvt_pk_bf16_f32 v48, v48, v48
  v_and_b32 v246, s72, v48
  s_waitcnt vmcnt(5)
  buffer_load_dwordx4 v[84:87], v11, s[8:11], s60 offen nt
  v_dot2_f32_bf16 v48, v100, v20, 0
  v_dot2_f32_bf16 v48, v101, v21, v48
  v_dot2_f32_bf16 v48, v102, v22, v48
  v_dot2_f32_bf16 v48, v103, v23, v48
  ds_read_b64 v[58:59], v5 offset:13896
  ds_add_rtn_u32 v62, v57, v15 offset:13904
  s_waitcnt vmcnt(4)
  s_and_b32 s60, s61, 0xffff
  s_mul_i32 s60, s60, 384
  buffer_load_dwordx4 v[88:91], v10, s[8:11], s60 offen nt
  v_dot2_f32_bf16 v48, v104, v24, v48
  v_dot2_f32_bf16 v48, v105, v25, v48
  v_dot2_f32_bf16 v48, v106, v26, v48
  v_dot2_f32_bf16 v48, v107, v27, v48
  s_waitcnt vmcnt(5)
  buffer_load_dwordx4 v[92:95], v10, s[8:11], s60 offen offset:128 nt
  v_dot2_f32_bf16 v48, v108, v28, v48
  v_dot2_f32_bf16 v48, v109, v29, v48
  v_dot2_f32_bf16 v48, v110, v30, v48
  v_dot2_f32_bf16 v48, v111, v31, v48
  s_nop 2
  v_add_f32_dpp v48, v48, v48 quad_perm:[1,0,3,2] row_mask:0xf bank_mask:0xf
  s_nop 1
  v_add_f32_dpp v48, v48, v48 quad_perm:[2,3,0,1] row_mask:0xf bank_mask:0xf
  s_nop 1
  v_add_f32_dpp v48, v48, v48 row_half_mirror row_mask:0xf bank_mask:0xf
  v_cvt_pk_bf16_f32 v48, v48, v48
  v_and_b32 v48, s72, v48
  v_mul_f32 v48, s66, v48
  v_cvt_pk_bf16_f32 v48, v48, v48
  v_and_b32 v247, s72, v48
  s_add_u32 s78, s78, 1
  s_cmp_lt_u32 s78, 8
  s_cbranch_scc1 L_dispk
  s_branch L_tailk
L_k3:
  s_waitcnt vmcnt(5)
  buffer_load_dwordx4 v[96:99], v11, s[8:11], s60 offen nt
  ds_write_b128 v253, v[244:247]
  v_add_u32 v253, 16, v253
  v_dot2_f32_bf16 v48, v64, v20, 0
  v_dot2_f32_bf16 v48, v65, v21, v48
  v_dot2_f32_bf16 v48, v66, v22, v48
  v_dot2_f32_bf16 v48, v67, v23, v48
  s_waitcnt vmcnt(5)
  s_lshr_b32 s60, s61, 16
  s_mul_i32 s60, s60, 384
  buffer_load_dwordx4 v[100:103], v10, s[8:11], s60 offen nt
  v_dot2_f32_bf16 v48, v68, v24, v48
  v_dot2_f32_bf16 v48, v69, v25, v48
  v_dot2_f32_bf16 v48, v70, v26, v48
  v_dot2_f32_bf16 v48, v71, v27, v48
  s_waitcnt vmcnt(5)
  v_readlane_b32 s61, v14, s62
  s_add_u32 s62, s62, 1
  buffer_load_dwordx4 v[104:107], v10, s[8:11], s60 offen offset:128 nt
  v_dot2_f32_bf16 v48, v72, v28, v48
  v_dot2_f32_bf16 v48, v73, v29, v48
  v_dot2_f32_bf16 v48, v74, v30, v48
  v_dot2_f32_bf16 v48, v75, v31, v48
  s_nop 2
  v_add_f32_dpp v48, v48, v48 quad_perm:[1,0,3,2] row_mask:0xf bank_mask:0xf
  s_nop 1
  v_add_f32_dpp v48, v48, v48 quad_perm:[2,3,0,1] row_mask:0xf bank_mask:0xf
  s_nop 1
  v_add_f32_dpp v48, v48, v48 row_half_mirror row_mask:0xf bank_mask:0xf
  v_cvt_pk_bf16_f32 v48, v48, v48
  v_and_b32 v48, s72, v48
  v_mul_f32 v48, s66, v48
  v_cvt_pk_bf16_f32 v48, v48, v48
  v_and_b32 v244, s72, v48
  s_waitcnt vmcnt(5)
  buffer_load_dwordx4 v[108:111], v11, s[8:11], s60 offen nt
  v_dot2_f32_bf16 v48, v76, v20, 0
  v_dot2_f32_bf16 v48, v77, v21, v48
  v_dot2_f32_bf16 v48, v78, v22, v48
  v_dot2_f32_bf16 v48, v79, v23, v48
  s_waitcnt vmcnt(5)
  s_and_b32 s60, s61, 0xffff
  s_mul_i32 s60, s60, 384
  buffer_load_dwordx4 v[64:67], v10, s[8:11], s60 offen nt
  v_dot2_f32_bf16 v48, v80, v24, v48
  v_dot2_f32_bf16 v48, v81, v25, v48
  v_dot2_f32_bf16 v48, v82, v26, v48
  v_dot2_f32_bf16 v48, v83, v27, v48
  s_waitcnt vmcnt(5)
  buffer_load_dwordx4 v[68:71], v10, s[8:11], s60 offen offset:128 nt
  v_dot2_f32_bf16 v48, v84, v28, v48
  v_dot2_f32_bf16 v48, v85, v29, v48
  v_dot2_f32_bf16 v48, v86, v30, v48
  v_dot2_f32_bf16 v48, v87, v31, v48
  s_nop 2
  v_add_f32_dpp v48, v48, v48 quad_perm:[1,0,3,2] row_mask:0xf bank_mask:0xf
  s_nop 1
  v_add_f32_dpp v48, v48, v48 quad_perm:[2,3,0,1] row_mask:0xf bank_mask:0xf
  s_nop 1
  v_add_f32_dpp v48, v48, v48 row_half_mirror row_mask:0xf bank_mask:0xf
  v_cvt_pk_bf16_f32 v48, v48, v48
  v_and_b32 v48, s72, v48
  v_mul_f32 v48, s66, v48
  v_cvt_pk_bf16_f32 v48, v48, v48
  v_and_b32 v245, s72, v48
  s_waitcnt vmcnt(5)
  buffer_load_dwordx4 v[72:75], v11, s[8:11], s60 offen nt
  v_dot2_f32_bf16 v48, v88, v20, 0
  v_dot2_f32_bf16 v48, v89, v21, v48
  v_dot2_f32_bf16 v48, v90, v22, v48
  v_dot2_f32_bf16 v48, v91, v23, v48
  s_waitcnt vmcnt(5)
  s_lshr_b32 s60, s61, 16
  s_mul_i32 s60, s60, 384
  buffer_load_dwordx4 v[76:79], v10, s[8:11], s60 offen nt
  v_dot2_f32_bf16 v48, v92, v24, v48
  v_dot2_f32_bf16 v48, v93, v25, v48
  v_dot2_f32_bf16 v48, v94, v26, v48
  v_dot2_f32_bf16 v48, v95, v27, v48
  s_waitcnt vmcnt(5)
  v_readlane_b32 s61, v14, s62
  s_add_u32 s62, s62, 1
  buffer_load_dwordx4 v[80:83], v10, s[8:11], s60 offen offset:128 nt
  v_dot2_f32_bf16 v48, v96, v28, v48
  v_dot2_f32_bf16 v48, v97, v29, v48
  v_dot2_f32_bf16 v48, v98, v30, v48
  v_dot2_f32_bf16 v48, v99, v31, v48
  s_nop 2
  v_add_f32_dpp v48, v48, v48 quad_perm:[1,0,3,2] row_mask:0xf bank_mask:0xf
  s_nop 1
  v_add_f32_dpp v48, v48, v48 quad_perm:[2,3,0,1] row_mask:0xf bank_mask:0xf
  s_nop 1
  v_add_f32_dpp v48, v48, v48 row_half_mirror row_mask:0xf bank_mask:0xf
  v_cvt_pk_bf16_f32 v48, v48, v48
  v_and_b32 v48, s72, v48
  v_mul_f32 v48, s66, v48
  v_cvt_pk_bf16_f32 v48, v48, v48
  v_and_b32 v246, s72, v48
  s_waitcnt vmcnt(5)
  buffer_load_dwordx4 v[84:87], v11, s[8:11], s60 offen nt
  v_dot2_f32_bf16 v48, v100, v20, 0
  v_dot2_f32_bf16 v48, v101, v21, v48
  v_dot2_f32_bf16 v48, v102, v22, v48
  v_dot2_f32_bf16 v48, v103, v23, v48
  ds_read_b64 v[58:59], v5 offset:13896
  ds_add_rtn_u32 v62, v57, v15 offset:13904
  s_waitcnt vmcnt(5)
  s_and_b32 s60, s61, 0xffff
  s_mul_i32 s60, s60, 384
  buffer_load_dwordx4 v[88:91], v10, s[8:11], s60 offen nt
  v_dot2_f32_bf16 v48, v104, v24, v48
  v_dot2_f32_bf16 v48, v105, v25, v48
  v_dot2_f32_bf16 v48, v106, v26, v48
  v_dot2_f32_bf16 v48, v107, v27, v48
  s_waitcnt vmcnt(5)
  buffer_load_dwordx4 v[92:95], v10, s[8:11], s60 offen offset:128 nt
  v_dot2_f32_bf16 v48, v108, v28, v48
  v_dot2_f32_bf16 v48, v109, v29, v48
  v_dot2_f32_bf16 v48, v110, v30, v48
  v_dot2_f32_bf16 v48, v111, v31, v48
  s_nop 2
  v_add_f32_dpp v48, v48, v48 quad_perm:[1,0,3,2] row_mask:0xf bank_mask:0xf
  s_nop 1
  v_add_f32_dpp v48, v48, v48 quad_perm:[2,3,0,1] row_mask:0xf bank_mask:0xf
  s_nop 1
  v_add_f32_dpp v48, v48, v48 row_half_mirror row_mask:0xf bank_mask:0xf
  v_cvt_pk_bf16_f32 v48, v48, v48
  v_and_b32 v48, s72, v48
  v_mul_f32 v48, s66, v48
  v_cvt_pk_bf16_f32 v48, v48, v48
  v_and_b32 v247, s72, v48
  s_add_u32 s78, s78, 1
  s_cmp_lt_u32 s78, 8
  s_cbranch_scc1 L_dispk
  s_branch L_tailk
L_k4:
  s_waitcnt vmcnt(5)
  buffer_load_dwordx4 v[96:99], v11, s[8:11], s60 offen nt
  ds_write_b128 v253, v[244:247]
  v_add_u32 v253, 16, v253
  v_dot2_f32_bf16 v48, v64, v20, 0
  v_dot2_f32_bf16 v48, v65, v21, v48
  v_dot2_f32_bf16 v48, v66, v22, v48
  v_dot2_f32_bf16 v48, v67, v23, v48
  s_waitcnt vmcnt(6)
  s_lshr_b32 s60, s61, 16
  s_mul_i32 s60, s60, 384
  buffer_load_dwordx4 v[100:103], v10, s[8:11], s60 offen nt
  v_dot2_f32_bf16 v48, v68, v24, v48
  v_dot2_f32_bf16 v48, v69, v25, v48
  v_dot2_f32_bf16 v48, v70, v26, v48
  v_dot2_f32_bf16 v48, v71, v27, v48
  s_waitcnt vmcnt(5)
  v_readlane_b32 s61, v14, s62
  s_add_u32 s62, s62, 1
  buffer_load_dwordx4 v[104:107], v10, s[8:11], s60 offen offset:128 nt
  v_dot2_f32_bf16 v48, v72, v28, v48
  v_dot2_f32_bf16 v48, v73, v29, v48
  v_dot2_f32_bf16 v48, v74, v30, v48
  v_dot2_f32_bf16 v48, v75, v31, v48
  s_nop 2
  v_add_f32_dpp v48, v48, v48 quad_perm:[1,0,3,2] row_mask:0xf bank_mask:0xf
  s_nop 1
  v_add_f32_dpp v48, v48, v48 quad_perm:[2,3,0,1] row_mask:0xf bank_mask:0xf
  s_nop 1
  v_add_f32_dpp v48, v48, v48 row_half_mirror row_mask:0xf bank_mask:0xf
  v_cvt_pk_bf16_f32 v48, v48, v48
  v_and_b32 v48, s72, v48
  v_mul_f32 v48, s66, v48
  v_cvt_pk_bf16_f32 v48, v48, v48
  v_and_b32 v244, s72, v48
  s_waitcnt vmcnt(6)
  buffer_load_dwordx4 v[108:111], v11, s[8:11], s60 offen nt
  v_dot2_f32_bf16 v48, v76, v20, 0
  v_dot2_f32_bf16 v48, v77, v21, v48
  v_dot2_f32_bf16 v48, v78, v22, v48
  v_dot2_f32_bf16 v48, v79, v23, v48
  s_waitcnt vmcnt(5)
  s_and_b32 s60, s61, 0xffff
  s_mul_i32 s60, s60, 384
  buffer_load_dwordx4 v[64:67], v10, s[8:11], s60 offen nt
  v_dot2_f32_bf16 v48, v80, v24, v48
  v_dot2_f32_bf16 v48, v81, v25, v48
  v_dot2_f32_bf16 v48, v82, v26, v48
  v_dot2_f32_bf16 v48, v83, v27, v48
  s_waitcnt vmcnt(6)
  buffer_load_dwordx4 v[68:71], v10, s[8:11], s60 offen offset:128 nt
  v_dot2_f32_bf16 v48, v84, v28, v48
  v_dot2_f32_bf16 v48, v85, v29, v48
  v_dot2_f32_bf16 v48, v86, v30, v48
  v_dot2_f32_bf16 v48, v87, v31, v48
  s_nop 2
  v_add_f32_dpp v48, v48, v48 quad_perm:[1,0,3,2] row_mask:0xf bank_mask:0xf
  s_nop 1
  v_add_f32_dpp v48, v48, v48 quad_perm:[2,3,0,1] row_mask:0xf bank_mask:0xf
  s_nop 1
  v_add_f32_dpp v48, v48, v48 row_half_mirror row_mask:0xf bank_mask:0xf
  v_cvt_pk_bf16_f32 v48, v48, v48
  v_and_b32 v48, s72, v48
  v_mul_f32 v48, s66, v48
  v_cvt_pk_bf16_f32 v48, v48, v48
  v_and_b32 v245, s72, v48
  s_waitcnt vmcnt(5)
  buffer_load_dwordx4 v[72:75], v11, s[8:11], s60 offen nt
  v_dot2_f32_bf16 v48, v88, v20, 0
  v_dot2_f32_bf16 v48, v89, v21, v48
  v_dot2_f32_bf16 v48, v90, v22, v48
  v_dot2_f32_bf16 v48, v91, v23, v48
  s_waitcnt vmcnt(6)
  s_lshr_b32 s60, s61, 16
  s_mul_i32 s60, s60, 384
  buffer_load_dwordx4 v[76:79], v10, s[8:11], s60 offen nt
  v_dot2_f32_bf16 v48, v92, v24, v48
  v_dot2_f32_bf16 v48, v93, v25, v48
  v_dot2_f32_bf16 v48, v94, v26, v48
  v_dot2_f32_bf16 v48, v95, v27, v48
  s_waitcnt vmcnt(5)
  v_readlane_b32 s61, v14, s62
  s_add_u32 s62, s62, 1
  buffer_load_dwordx4 v[80:83], v10, s[8:11], s60 offen offset:128 nt
  v_dot2_f32_bf16 v48, v96, v28, v48
  v_dot2_f32_bf16 v48, v97, v29, v48
  v_dot2_f32_bf16 v48, v98, v30, v48
  v_dot2_f32_bf16 v48, v99, v31, v48
  s_nop 2
  v_add_f32_dpp v48, v48, v48 quad_perm:[1,0,3,2] row_mask:0xf bank_mask:0xf
  s_nop 1
  v_add_f32_dpp v48, v48, v48 quad_perm:[2,3,0,1] row_mask:0xf bank_mask:0xf
  s_nop 1
  v_add_f32_dpp v48, v48, v48 row_half_mirror row_mask:0xf bank_mask:0xf
  v_cvt_pk_bf16_f32 v48, v48, v48
  v_and_b32 v48, s72, v48
  v_mul_f32 v48, s66, v48
  v_cvt_pk_bf16_f32 v48, v48, v48
  v_and_b32 v246, s72, v48
  s_waitcnt vmcnt(6)
  buffer_load_dwordx4 v[84:87], v11, s[8:11], s60 offen nt
  v_dot2_f32_bf16 v48, v100, v20, 0
  v_dot2_f32_bf16 v48, v101, v21, v48
  v_dot2_f32_bf16 v48, v102, v22, v48
  v_dot2_f32_bf16 v48, v103, v23, v48
  ds_read_b64 v[58:59], v5 offset:13896
  ds_add_rtn_u32 v62, v57, v15 offset:13904
  s_waitcnt vmcnt(5)
  s_and_b32 s60, s61, 0xffff
  s_mul_i32 s60, s60, 384
  buffer_load_dwordx4 v[88:91], v10, s[8:11], s60 offen nt
  v_dot2_f32_bf16 v48, v104, v24, v48
  v_dot2_f32_bf16 v48, v105, v25, v48
  v_dot2_f32_bf16 v48, v106, v26, v48
  v_dot2_f32_bf16 v48, v107, v27, v48
  s_waitcnt vmcnt(6)
  buffer_load_dwordx4 v[92:95], v10, s[8:11], s60 offen offset:128 nt
  v_dot2_f32_bf16 v48, v108, v28, v48
  v_dot2_f32_bf16 v48, v109, v29, v48
  v_dot2_f32_bf16 v48, v110, v30, v48
  v_dot2_f32_bf16 v48, v111, v31, v48
  s_nop 2
  v_add_f32_dpp v48, v48, v48 quad_perm:[1,0,3,2] row_mask:0xf bank_mask:0xf
  s_nop 1
  v_add_f32_dpp v48, v48, v48 quad_perm:[2,3,0,1] row_mask:0xf bank_mask:0xf
  s_nop 1
  v_add_f32_dpp v48, v48, v48 row_half_mirror row_mask:0xf bank_mask:0xf
  v_cvt_pk_bf16_f32 v48, v48, v48
  v_and_b32 v48, s72, v48
  v_mul_f32 v48, s66, v48
  v_cvt_pk_bf16_f32 v48, v48, v48
  v_and_b32 v247, s72, v48
  s_add_u32 s78, s78, 1
  s_cmp_lt_u32 s78, 8
  s_cbranch_scc1 L_dispk
  s_branch L_tailk
L_k5:
  s_waitcnt vmcnt(6)
  buffer_load_dwordx4 v[96:99], v11, s[8:11], s60 offen nt
  ds_write_b128 v253, v[244:247]
  v_add_u32 v253, 16, v253
  v_dot2_f32_bf16 v48, v64, v20, 0
  v_dot2_f32_bf16 v48, v65, v21, v48
  v_dot2_f32_bf16 v48, v66, v22, v48
  v_dot2_f32_bf16 v48, v67, v23, v48
  s_waitcnt vmcnt(6)
  s_lshr_b32 s60, s61, 16
  s_mul_i32 s60, s60, 384
  buffer_load_dwordx4 v[100:103], v10, s[8:11], s60 offen nt
  v_dot2_f32_bf16 v48, v68, v24, v48
  v_dot2_f32_bf16 v48, v69, v25, v48
  v_dot2_f32_bf16 v48, v70, v26, v48
  v_dot2_f32_bf16 v48, v71, v27, v48
  s_waitcnt vmcnt(6)
  v_readlane_b32 s61, v14, s62
  s_add_u32 s62, s62, 1
  buffer_load_dwordx4 v[104:107], v10, s[8:11], s60 offen offset:128 nt
  v_dot2_f32_bf16 v48, v72, v28, v48
  v_dot2_f32_bf16 v48, v73, v29, v48
  v_dot2_f32_bf16 v48, v74, v30, v48
  v_dot2_f32_bf16 v48, v75, v31, v48
  s_nop 2
  v_add_f32_dpp v48, v48, v48 quad_perm:[1,0,3,2] row_mask:0xf bank_mask:0xf
  s_nop 1
  v_add_f32_dpp v48, v48, v48 quad_perm:[2,3,0,1] row_mask:0xf bank_mask:0xf
  s_nop 1
  v_add_f32_dpp v48, v48, v48 row_half_mirror row_mask:0xf bank_mask:0xf
  v_cvt_pk_bf16_f32 v48, v48, v48
  v_and_b32 v48, s72, v48
  v_mul_f32 v48, s66, v48
  v_cvt_pk_bf16_f32 v48, v48, v48
  v_and_b32 v244, s72, v48
  s_waitcnt vmcnt(6)
  buffer_load_dwordx4 v[108:111], v11, s[8:11], s60 offen nt
  v_dot2_f32_bf16 v48, v76, v20, 0
  v_dot2_f32_bf16 v48, v77, v21, v48
  v_dot2_f32_bf16 v48, v78, v22, v48
  v_dot2_f32_bf16 v48, v79, v23, v48
  s_waitcnt vmcnt(6)
  s_and_b32 s60, s61, 0xffff
  s_mul_i32 s60, s60, 384
  buffer_load_dwordx4 v[64:67], v10, s[8:11], s60 offen nt
  v_dot2_f32_bf16 v48, v80, v24, v48
  v_dot2_f32_bf16 v48, v81, v25, v48
  v_dot2_f32_bf16 v48, v82, v26, v48
  v_dot2_f32_bf16 v48, v83, v27, v48
  s_waitcnt vmcnt(6)
  buffer_load_dwordx4 v[68:71], v10, s[8:11], s60 offen offset:128 nt
  v_dot2_f32_bf16 v48, v84, v28, v48
  v_dot2_f32_bf16 v48, v85, v29, v48
  v_dot2_f32_bf16 v48, v86, v30, v48
  v_dot2_f32_bf16 v48, v87, v31, v48
  s_nop 2
  v_add_f32_dpp v48, v48, v48 quad_perm:[1,0,3,2] row_mask:0xf bank_mask:0xf
  s_nop 1
  v_add_f32_dpp v48, v48, v48 quad_perm:[2,3,0,1] row_mask:0xf bank_mask:0xf
  s_nop 1
  v_add_f32_dpp v48, v48, v48 row_half_mirror row_mask:0xf bank_mask:0xf
  v_cvt_pk_bf16_f32 v48, v48, v48
  v_and_b32 v48, s72, v48
  v_mul_f32 v48, s66, v48
  v_cvt_pk_bf16_f32 v48, v48, v48
  v_and_b32 v245, s72, v48
  s_waitcnt vmcnt(6)
  buffer_load_dwordx4 v[72:75], v11, s[8:11], s60 offen nt
  v_dot2_f32_bf16 v48, v88, v20, 0
  v_dot2_f32_bf16 v48, v89, v21, v48
  v_dot2_f32_bf16 v48, v90, v22, v48
  v_dot2_f32_bf16 v48, v91, v23, v48
  s_waitcnt vmcnt(6)
  s_lshr_b32 s60, s61, 16
  s_mul_i32 s60, s60, 384
  buffer_load_dwordx4 v[76:79], v10, s[8:11], s60 offen nt
  v_dot2_f32_bf16 v48, v92, v24, v48
  v_dot2_f32_bf16 v48, v93, v25, v48
  v_dot2_f32_bf16 v48, v94, v26, v48
  v_dot2_f32_bf16 v48, v95, v27, v48
  s_waitcnt vmcnt(6)
  v_readlane_b32 s61, v14, s62
  s_add_u32 s62, s62, 1
  buffer_load_dwordx4 v[80:83], v10, s[8:11], s60 offen offset:128 nt
  v_dot2_f32_bf16 v48, v96, v28, v48
  v_dot2_f32_bf16 v48, v97, v29, v48
  v_dot2_f32_bf16 v48, v98, v30, v48
  v_dot2_f32_bf16 v48, v99, v31, v48
  s_nop 2
  v_add_f32_dpp v48, v48, v48 quad_perm:[1,0,3,2] row_mask:0xf bank_mask:0xf
  s_nop 1
  v_add_f32_dpp v48, v48, v48 quad_perm:[2,3,0,1] row_mask:0xf bank_mask:0xf
  s_nop 1
  v_add_f32_dpp v48, v48, v48 row_half_mirror row_mask:0xf bank_mask:0xf
  v_cvt_pk_bf16_f32 v48, v48, v48
  v_and_b32 v48, s72, v48
  v_mul_f32 v48, s66, v48
  v_cvt_pk_bf16_f32 v48, v48, v48
  v_and_b32 v246, s72, v48
  s_waitcnt vmcnt(6)
  buffer_load_dwordx4 v[84:87], v11, s[8:11], s60 offen nt
  v_dot2_f32_bf16 v48, v100, v20, 0
  v_dot2_f32_bf16 v48, v101, v21, v48
  v_dot2_f32_bf16 v48, v102, v22, v48
  v_dot2_f32_bf16 v48, v103, v23, v48
  ds_read_b64 v[58:59], v5 offset:13896
  ds_add_rtn_u32 v62, v57, v15 offset:13904
  s_waitcnt vmcnt(6)
  s_and_b32 s60, s61, 0xffff
  s_mul_i32 s60, s60, 384
  buffer_load_dwordx4 v[88:91], v10, s[8:11], s60 offen nt
  v_dot2_f32_bf16 v48, v104, v24, v48
  v_dot2_f32_bf16 v48, v105, v25, v48
  v_dot2_f32_bf16 v48, v106, v26, v48
  v_dot2_f32_bf16 v48, v107, v27, v48
  s_waitcnt vmcnt(6)
  buffer_load_dwordx4 v[92:95], v10, s[8:11], s60 offen offset:128 nt
  v_dot2_f32_bf16 v48, v108, v28, v48
  v_dot2_f32_bf16 v48, v109, v29, v48
  v_dot2_f32_bf16 v48, v110, v30, v48
  v_dot2_f32_bf16 v48, v111, v31, v48
  s_nop 2
  v_add_f32_dpp v48, v48, v48 quad_perm:[1,0,3,2] row_mask:0xf bank_mask:0xf
  s_nop 1
  v_add_f32_dpp v48, v48, v48 quad_perm:[2,3,0,1] row_mask:0xf bank_mask:0xf
  s_nop 1
  v_add_f32_dpp v48, v48, v48 row_half_mirror row_mask:0xf bank_mask:0xf
  v_cvt_pk_bf16_f32 v48, v48, v48
  v_and_b32 v48, s72, v48
  v_mul_f32 v48, s66, v48
  v_cvt_pk_bf16_f32 v48, v48, v48
  v_and_b32 v247, s72, v48
  s_add_u32 s78, s78, 1
  s_cmp_lt_u32 s78, 8
  s_cbranch_scc1 L_dispk
  s_branch L_tailk
L_k6:
  s_waitcnt vmcnt(7)
  buffer_load_dwordx4 v[96:99], v11, s[8:11], s60 offen nt
  ds_write_b128 v253, v[244:247]
  v_add_u32 v253, 16, v253
  v_dot2_f32_bf16 v48, v64, v20, 0
  v_dot2_f32_bf16 v48, v65, v21, v48
  v_dot2_f32_bf16 v48, v66, v22, v48
  v_dot2_f32_bf16 v48, v67, v23, v48
  s_waitcnt vmcnt(7)
  s_lshr_b32 s60, s61, 16
  s_mul_i32 s60, s60, 384
  buffer_load_dwordx4 v[100:103], v10, s[8:11], s60 offen nt
  v_dot2_f32_bf16 v48, v68, v24, v48
  v_dot2_f32_bf16 v48, v69, v25, v48
  v_dot2_f32_bf16 v48, v70, v26, v48
  v_dot2_f32_bf16 v48, v71, v27, v48
  s_waitcnt vmcnt(7)
  v_readlane_b32 s61, v14, s62
  s_add_u32 s62, s62, 1
  buffer_load_dwordx4 v[104:107], v10, s[8:11], s60 offen offset:128 nt
  v_dot2_f32_bf16 v48, v72, v28, v48
  v_dot2_f32_bf16 v48, v73, v29, v48
  v_dot2_f32_bf16 v48, v74, v30, v48
  v_dot2_f32_bf16 v48, v75, v31, v48
  s_nop 2
  v_add_f32_dpp v48, v48, v48 quad_perm:[1,0,3,2] row_mask:0xf bank_mask:0xf
  s_nop 1
  v_add_f32_dpp v48, v48, v48 quad_perm:[2,3,0,1] row_mask:0xf bank_mask:0xf
  s_nop 1
  v_add_f32_dpp v48, v48, v48 row_half_mirror row_mask:0xf bank_mask:0xf
  v_cvt_pk_bf16_f32 v48, v48, v48
  v_and_b32 v48, s72, v48
  v_mul_f32 v48, s66, v48
  v_cvt_pk_bf16_f32 v48, v48, v48
  v_and_b32 v244, s72, v48
  s_waitcnt vmcnt(7)
  buffer_load_dwordx4 v[108:111], v11, s[8:11], s60 offen nt
  v_dot2_f32_bf16 v48, v76, v20, 0
  v_dot2_f32_bf16 v48, v77, v21, v48
  v_dot2_f32_bf16 v48, v78, v22, v48
  v_dot2_f32_bf16 v48, v79, v23, v48
  s_waitcnt vmcnt(7)
  s_and_b32 s60, s61, 0xffff
  s_mul_i32 s60, s60, 384
  buffer_load_dwordx4 v[64:67], v10, s[8:11], s60 offen nt
  v_dot2_f32_bf16 v48, v80, v24, v48
  v_dot2_f32_bf16 v48, v81, v25, v48
  v_dot2_f32_bf16 v48, v82, v26, v48
  v_dot2_f32_bf16 v48, v83, v27, v48
  s_waitcnt vmcnt(7)
  buffer_load_dwordx4 v[68:71], v10, s[8:11], s60 offen offset:128 nt
  v_dot2_f32_bf16 v48, v84, v28, v48
  v_dot2_f32_bf16 v48, v85, v29, v48
  v_dot2_f32_bf16 v48, v86, v30, v48
  v_dot2_f32_bf16 v48, v87, v31, v48
  s_nop 2
  v_add_f32_dpp v48, v48, v48 quad_perm:[1,0,3,2] row_mask:0xf bank_mask:0xf
  s_nop 1
  v_add_f32_dpp v48, v48, v48 quad_perm:[2,3,0,1] row_mask:0xf bank_mask:0xf
  s_nop 1
  v_add_f32_dpp v48, v48, v48 row_half_mirror row_mask:0xf bank_mask:0xf
  v_cvt_pk_bf16_f32 v48, v48, v48
  v_and_b32 v48, s72, v48
  v_mul_f32 v48, s66, v48
  v_cvt_pk_bf16_f32 v48, v48, v48
  v_and_b32 v245, s72, v48
  s_waitcnt vmcnt(7)
  buffer_load_dwordx4 v[72:75], v11, s[8:11], s60 offen nt
  v_dot2_f32_bf16 v48, v88, v20, 0
  v_dot2_f32_bf16 v48, v89, v21, v48
  v_dot2_f32_bf16 v48, v90, v22, v48
  v_dot2_f32_bf16 v48, v91, v23, v48
  s_waitcnt vmcnt(7)
  s_lshr_b32 s60, s61, 16
  s_mul_i32 s60, s60, 384
  buffer_load_dwordx4 v[76:79], v10, s[8:11], s60 offen nt
  v_dot2_f32_bf16 v48, v92, v24, v48
  v_dot2_f32_bf16 v48, v93, v25, v48
  v_dot2_f32_bf16 v48, v94, v26, v48
  v_dot2_f32_bf16 v48, v95, v27, v48
  s_waitcnt vmcnt(7)
  v_readlane_b32 s61, v14, s62
  s_add_u32 s62, s62, 1
  buffer_load_dwordx4 v[80:83], v10, s[8:11], s60 offen offset:128 nt
  v_dot2_f32_bf16 v48, v96, v28, v48
  v_dot2_f32_bf16 v48, v97, v29, v48
  v_dot2_f32_bf16 v48, v98, v30, v48
  v_dot2_f32_bf16 v48, v99, v31, v48
  s_nop 2
  v_add_f32_dpp v48, v48, v48 quad_perm:[1,0,3,2] row_mask:0xf bank_mask:0xf
  s_nop 1
  v_add_f32_dpp v48, v48, v48 quad_perm:[2,3,0,1] row_mask:0xf bank_mask:0xf
  s_nop 1
  v_add_f32_dpp v48, v48, v48 row_half_mirror row_mask:0xf bank_mask:0xf
  v_cvt_pk_bf16_f32 v48, v48, v48
  v_and_b32 v48, s72, v48
  v_mul_f32 v48, s66, v48
  v_cvt_pk_bf16_f32 v48, v48, v48
  v_and_b32 v246, s72, v48
  s_waitcnt vmcnt(7)
  buffer_load_dwordx4 v[84:87], v11, s[8:11], s60 offen nt
  v_dot2_f32_bf16 v48, v100, v20, 0
  v_dot2_f32_bf16 v48, v101, v21, v48
  v_dot2_f32_bf16 v48, v102, v22, v48
  v_dot2_f32_bf16 v48, v103, v23, v48
  ds_read_b64 v[58:59], v5 offset:13896
  ds_add_rtn_u32 v62, v57, v15 offset:13904
  s_waitcnt vmcnt(7)
  s_and_b32 s60, s61, 0xffff
  s_mul_i32 s60, s60, 384
  buffer_load_dwordx4 v[88:91], v10, s[8:11], s60 offen nt
  v_dot2_f32_bf16 v48, v104, v24, v48
  v_dot2_f32_bf16 v48, v105, v25, v48
  v_dot2_f32_bf16 v48, v106, v26, v48
  v_dot2_f32_bf16 v48, v107, v27, v48
  s_waitcnt vmcnt(7)
  buffer_load_dwordx4 v[92:95], v10, s[8:11], s60 offen offset:128 nt
  v_dot2_f32_bf16 v48, v108, v28, v48
  v_dot2_f32_bf16 v48, v109, v29, v48
  v_dot2_f32_bf16 v48, v110, v30, v48
  v_dot2_f32_bf16 v48, v111, v31, v48
  s_nop 2
  v_add_f32_dpp v48, v48, v48 quad_perm:[1,0,3,2] row_mask:0xf bank_mask:0xf
  s_nop 1
  v_add_f32_dpp v48, v48, v48 quad_perm:[2,3,0,1] row_mask:0xf bank_mask:0xf
  s_nop 1
  v_add_f32_dpp v48, v48, v48 row_half_mirror row_mask:0xf bank_mask:0xf
  v_cvt_pk_bf16_f32 v48, v48, v48
  v_and_b32 v48, s72, v48
  v_mul_f32 v48, s66, v48
  v_cvt_pk_bf16_f32 v48, v48, v48
  v_and_b32 v247, s72, v48
  s_add_u32 s78, s78, 1
  s_cmp_lt_u32 s78, 8
  s_cbranch_scc1 L_dispk
L_tailk:
  ds_write_b128 v253, v[244:247]
  s_waitcnt vmcnt(5)
  buffer_load_dwordx4 v[96:99], v11, s[8:11], s60 offen nt
  v_dot2_f32_bf16 v48, v64, v20, 0
  v_dot2_f32_bf16 v48, v65, v21, v48
  v_dot2_f32_bf16 v48, v66, v22, v48
  v_dot2_f32_bf16 v48, v67, v23, v48
  v_dot2_f32_bf16 v48, v68, v24, v48
  v_dot2_f32_bf16 v48, v69, v25, v48
  v_dot2_f32_bf16 v48, v70, v26, v48
  v_dot2_f32_bf16 v48, v71, v27, v48
  v_dot2_f32_bf16 v48, v72, v28, v48
  v_dot2_f32_bf16 v48, v73, v29, v48
  v_dot2_f32_bf16 v48, v74, v30, v48
  v_dot2_f32_bf16 v48, v75, v31, v48
  s_nop 2
  v_add_f32_dpp v48, v48, v48 quad_perm:[1,0,3,2] row_mask:0xf bank_mask:0xf
  s_nop 1
  v_add_f32_dpp v48, v48, v48 quad_perm:[2,3,0,1] row_mask:0xf bank_mask:0xf
  s_nop 1
  v_add_f32_dpp v48, v48, v48 row_half_mirror row_mask:0xf bank_mask:0xf
  v_cvt_pk_bf16_f32 v48, v48, v48
  v_and_b32 v48, s72, v48
  v_mul_f32 v48, s66, v48
  v_cvt_pk_bf16_f32 v48, v48, v48
  v_and_b32 v244, s72, v48
  ds_write_b32 v252, v244 offset:496
  s_waitcnt vmcnt(5)
  s_lshr_b32 s60, s61, 16
  s_mul_i32 s60, s60, 384
  buffer_load_dwordx4 v[100:103], v10, s[8:11], s60 offen nt
  v_dot2_f32_bf16 v48, v76, v20, 0
  v_dot2_f32_bf16 v48, v77, v21, v48
  v_dot2_f32_bf16 v48, v78, v22, v48
  v_dot2_f32_bf16 v48, v79, v23, v48
  s_waitcnt vmcnt(5)
  buffer_load_dwordx4 v[104:107], v10, s[8:11], s60 offen offset:128 nt
  v_dot2_f32_bf16 v48, v80, v24, v48
  v_dot2_f32_bf16 v48, v81, v25, v48
  v_dot2_f32_bf16 v48, v82, v26, v48
  v_dot2_f32_bf16 v48, v83, v27, v48
  s_waitcnt vmcnt(5)
  buffer_load_dwordx4 v[108:111], v11, s[8:11], s60 offen nt
  v_dot2_f32_bf16 v48, v84, v28, v48
  v_dot2_f32_bf16 v48, v85, v29, v48
  v_dot2_f32_bf16 v48, v86, v30, v48
  v_dot2_f32_bf16 v48, v87, v31, v48
  s_nop 2
  v_add_f32_dpp v48, v48, v48 quad_perm:[1,0,3,2] row_mask:0xf bank_mask:0xf
  s_nop 1
  v_add_f32_dpp v48, v48, v48 quad_perm:[2,3,0,1] row_mask:0xf bank_mask:0xf
  s_nop 1
  v_add_f32_dpp v48, v48, v48 row_half_mirror row_mask:0xf bank_mask:0xf
  v_cvt_pk_bf16_f32 v48, v48, v48
  v_and_b32 v48, s72, v48
  v_mul_f32 v48, s66, v48
  v_cvt_pk_bf16_f32 v48, v48, v48
  v_and_b32 v245, s72, v48
  ds_write_b32 v252, v245 offset:500
  s_waitcnt vmcnt(5)
  buffer_load_dwordx4 v[64:67], v12, s[12:15], s63 offen nt
  v_dot2_f32_bf16 v48, v88, v20, 0
  v_dot2_f32_bf16 v48, v89, v21, v48
  v_dot2_f32_bf16 v48, v90, v22, v48
  v_dot2_f32_bf16 v48, v91, v23, v48
  s_waitcnt vmcnt(5)
  buffer_load_dwordx4 v[68:71], v12, s[12:15], s63 offen offset:128 nt
  v_dot2_f32_bf16 v48, v92, v24, v48
  v_dot2_f32_bf16 v48, v93, v25, v48
  v_dot2_f32_bf16 v48, v94, v26, v48
  v_dot2_f32_bf16 v48, v95, v27, v48
  s_waitcnt vmcnt(5)
  buffer_load_dwordx4 v[72:75], v13, s[12:15], s63 offen nt
  v_dot2_f32_bf16 v48, v96, v28, v48
  v_dot2_f32_bf16 v48, v97, v29, v48
  v_dot2_f32_bf16 v48, v98, v30, v48
  v_dot2_f32_bf16 v48, v99, v31, v48
  s_nop 2
  v_add_f32_dpp v48, v48, v48 quad_perm:[1,0,3,2] row_mask:0xf bank_mask:0xf
  s_nop 1
  v_add_f32_dpp v48, v48, v48 quad_perm:[2,3,0,1] row_mask:0xf bank_mask:0xf
  s_nop 1
  v_add_f32_dpp v48, v48, v48 row_half_mirror row_mask:0xf bank_mask:0xf
  v_cvt_pk_bf16_f32 v48, v48, v48
  v_and_b32 v48, s72, v48
  v_mul_f32 v48, s66, v48
  v_cvt_pk_bf16_f32 v48, v48, v48
  v_and_b32 v246, s72, v48
  ds_write_b32 v252, v246 offset:504
  s_waitcnt vmcnt(5)
  buffer_load_dwordx4 v[76:79], v12, s[12:15], s64 offen nt
  v_dot2_f32_bf16 v48, v100, v20, 0
  v_dot2_f32_bf16 v48, v101, v21, v48
  v_dot2_f32_bf16 v48, v102, v22, v48
  v_dot2_f32_bf16 v48, v103, v23, v48
  s_waitcnt vmcnt(5)
  buffer_load_dwordx4 v[80:83], v12, s[12:15], s64 offen offset:128 nt
  v_dot2_f32_bf16 v48, v104, v24, v48
  v_dot2_f32_bf16 v48, v105, v25, v48
  v_dot2_f32_bf16 v48, v106, v26, v48
  v_dot2_f32_bf16 v48, v107, v27, v48
  s_waitcnt vmcnt(5)
  v_readlane_b32 s61, v14, 0
  buffer_load_dwordx4 v[84:87], v13, s[12:15], s64 offen nt
  v_dot2_f32_bf16 v48, v108, v28, v48
  v_dot2_f32_bf16 v48, v109, v29, v48
  v_dot2_f32_bf16 v48, v110, v30, v48
  v_dot2_f32_bf16 v48, v111, v31, v48
  s_nop 2
  v_add_f32_dpp v48, v48, v48 quad_perm:[1,0,3,2] row_mask:0xf bank_mask:0xf
  s_nop 1
  v_add_f32_dpp v48, v48, v48 quad_perm:[2,3,0,1] row_mask:0xf bank_mask:0xf
  s_nop 1
  v_add_f32_dpp v48, v48, v48 row_half_mirror row_mask:0xf bank_mask:0xf
  v_cvt_pk_bf16_f32 v48, v48, v48
  v_and_b32 v48, s72, v48
  v_mul_f32 v48, s66, v48
  v_cvt_pk_bf16_f32 v48, v48, v48
  v_and_b32 v247, s72, v48
  ds_write_b32 v252, v247 offset:508
  v_lshl_add_u32 v6, v1, 2, v252
  s_waitcnt lgkmcnt(0)
  ds_read_b128 v[112:115], v6 offset:0
  ds_read_b128 v[116:119], v6 offset:16
  ds_read_b128 v[120:123], v6 offset:32
  ds_read_b128 v[124:127], v6 offset:48
  s_waitcnt vmcnt(5)
  s_and_b32 s60, s61, 0xffff
  s_mul_i32 s60, s60, 384
  buffer_load_dwordx4 v[88:91], v10, s[12:15], s60 offen nt
  s_waitcnt lgkmcnt(0)
  v_max3_f32 v50, v112, v113, v114
  v_max3_f32 v49, v115, v116, v117
  v_max3_f32 v50, v118, v119, v50
  v_max3_f32 v49, v120, v121, v49
  v_max3_f32 v50, v122, v123, v50
  v_max3_f32 v49, v124, v125, v49
  v_max3_f32 v50, v126, v127, v50
  v_max_f32 v50, v50, v49
  s_nop 1
  v_max_f32_dpp v50, v50, v50 quad_perm:[1,0,3,2] row_mask:0xf bank_mask:0xf
  s_nop 1
  v_max_f32_dpp v50, v50, v50 quad_perm:[2,3,0,1] row_mask:0xf bank_mask:0xf
  s_nop 1
  v_max_f32_dpp v50, v50, v50 row_half_mirror row_mask:0xf bank_mask:0xf
  s_nop 1
  v_max_f32_dpp v50, v50, v50 row_mirror row_mask:0xf bank_mask:0xf
  s_nop 0
  v_readlane_b32 s74, v50, 0
  v_readlane_b32 s75, v50, 16
  v_readlane_b32 s76, v50, 32
  v_readlane_b32 s77, v50, 48
  v_mov_b32 v50, s74
  v_max_f32 v50, s75, v50
  v_max_f32 v50, s76, v50
  v_max_f32 v50, s77, v50
  v_mul_f32 v52, s65, v50
  v_sub_f32 v52, 0, v52
  s_waitcnt vmcnt(5)
  buffer_load_dwordx4 v[92:95], v10, s[12:15], s60 offen offset:128 nt
  v_fma_f32 v112, v112, s65, v52
  v_fma_f32 v113, v113, s65, v52
  v_fma_f32 v114, v114, s65, v52
  v_fma_f32 v115, v115, s65, v52
  v_fma_f32 v116, v116, s65, v52
  v_fma_f32 v117, v117, s65, v52
  v_fma_f32 v118, v118, s65, v52
  v_fma_f32 v119, v119, s65, v52
  v_fma_f32 v120, v120, s65, v52
  v_fma_f32 v121, v121, s65, v52
  v_fma_f32 v122, v122, s65, v52
  v_fma_f32 v123, v123, s65, v52
  v_fma_f32 v124, v124, s65, v52
  v_fma_f32 v125, v125, s65, v52
  v_fma_f32 v126, v126, s65, v52
  v_fma_f32 v127, v127, s65, v52
  v_exp_f32 v112, v112
  v_exp_f32 v113, v113
  v_exp_f32 v114, v114
  v_exp_f32 v115, v115
  v_exp_f32 v116, v116
  v_exp_f32 v117, v117
  v_exp_f32 v118, v118
  v_exp_f32 v119, v119
  v_exp_f32 v120, v120
  v_exp_f32 v121, v121
  v_exp_f32 v122, v122
  v_exp_f32 v123, v123
  v_exp_f32 v124, v124
  v_exp_f32 v125, v125
  v_exp_f32 v126, v126
  v_exp_f32 v127, v127
  v_cvt_pk_bf16_f32 v128, v112, v112
  v_cvt_pk_bf16_f32 v129, v113, v113
  v_cvt_pk_bf16_f32 v130, v114, v114
  v_cvt_pk_bf16_f32 v131, v115, v115
  v_cvt_pk_bf16_f32 v132, v116, v116
  v_cvt_pk_bf16_f32 v133, v117, v117
  v_cvt_pk_bf16_f32 v134, v118, v118
  v_cvt_pk_bf16_f32 v135, v119, v119
  v_cvt_pk_bf16_f32 v136, v120, v120
  v_cvt_pk_bf16_f32 v137, v121, v121
  v_cvt_pk_bf16_f32 v138, v122, v122
  v_cvt_pk_bf16_f32 v139, v123, v123
  v_cvt_pk_bf16_f32 v140, v124, v124
  v_cvt_pk_bf16_f32 v141, v125, v125
  v_cvt_pk_bf16_f32 v142, v126, v126
  v_cvt_pk_bf16_f32 v143, v127, v127
  ds_write_b128 v6, v[128:131] offset:0
  ds_write_b128 v6, v[132:135] offset:16
  ds_write_b128 v6, v[136:139] offset:32
  ds_write_b128 v6, v[140:143] offset:48
  ds_read_b128 v[248:251], v252
  s_waitcnt vmcnt(5)
  buffer_load_dwordx4 v[96:99], v11, s[12:15], s60 offen nt
  v_add_f32 v112, v112, v120
  v_add_f32 v113, v113, v121
  v_add_f32 v114, v114, v122
  v_add_f32 v115, v115, v123
  v_add_f32 v116, v116, v124
  v_add_f32 v117, v117, v125
  v_add_f32 v118, v118, v126
  v_add_f32 v119, v119, v127
  v_add_f32 v112, v112, v116
  v_add_f32 v113, v113, v117
  v_add_f32 v114, v114, v118
  v_add_f32 v115, v115, v119
  v_add_f32 v112, v112, v114
  v_add_f32 v113, v113, v115
  v_add_f32 v53, v112, v113
  s_nop 1
  v_add_f32_dpp v53, v53, v53 quad_perm:[1,0,3,2] row_mask:0xf bank_mask:0xf
  s_nop 1
  v_add_f32_dpp v53, v53, v53 quad_perm:[2,3,0,1] row_mask:0xf bank_mask:0xf
  s_nop 1
  v_add_f32_dpp v53, v53, v53 row_half_mirror row_mask:0xf bank_mask:0xf
  s_nop 1
  v_add_f32_dpp v53, v53, v53 row_mirror row_mask:0xf bank_mask:0xf
  s_nop 0
  v_readlane_b32 s74, v53, 0
  v_readlane_b32 s75, v53, 16
  v_readlane_b32 s76, v53, 32
  v_readlane_b32 s77, v53, 48
  v_mov_b32 v53, s74
  v_add_f32 v53, s75, v53
  v_add_f32 v53, s76, v53
  v_add_f32 v53, s77, v53
  s_lshl_b32 s69, s56, 3
  v_mov_b32 v6, s69
  v_mov_b32 v7, 1
  s_mov_b64 exec, 1
  ds_write_b64 v6, v[52:53] offset:13824
  ds_add_u32 v5, v7 offset:13856
  s_mov_b64 exec, -1
  s_waitcnt lgkmcnt(0)
  v_and_b32 v44, v248, v16
  v_and_b32 v45, v248, v17
  v_and_b32 v46, v248, v18
  v_and_b32 v47, v248, v19
  s_nop 1
  v_mfma_f32_16x16x32_bf16 v[32:35], v[44:47], v[64:67], v[32:35]
  v_mfma_f32_16x16x32_bf16 v[36:39], v[44:47], v[68:71], v[36:39]
  v_mfma_f32_16x16x32_bf16 v[40:43], v[44:47], v[72:75], v[40:43]
  s_waitcnt vmcnt(5)
  s_lshr_b32 s60, s61, 16
  s_mul_i32 s60, s60, 384
  buffer_load_dwordx4 v[100:103], v10, s[12:15], s60 offen nt
  s_waitcnt vmcnt(5)
  v_readlane_b32 s61, v14, 1
  buffer_load_dwordx4 v[104:107], v10, s[12:15], s60 offen offset:128 nt
  s_waitcnt vmcnt(5)
  buffer_load_dwordx4 v[108:111], v11, s[12:15], s60 offen nt
  v_and_b32 v240, v249, v16
  v_and_b32 v241, v249, v17
  v_and_b32 v242, v249, v18
  v_and_b32 v243, v249, v19
  s_nop 1
  v_mfma_f32_16x16x32_bf16 v[32:35], v[240:243], v[76:79], v[32:35]
  s_waitcnt vmcnt(5)
  s_and_b32 s60, s61, 0xffff
  s_mul_i32 s60, s60, 384
  buffer_load_dwordx4 v[64:67], v10, s[12:15], s60 offen nt
  v_mfma_f32_16x16x32_bf16 v[36:39], v[240:243], v[80:83], v[36:39]
  s_waitcnt vmcnt(5)
  buffer_load_dwordx4 v[68:71], v10, s[12:15], s60 offen offset:128 nt
  v_mfma_f32_16x16x32_bf16 v[40:43], v[240:243], v[84:87], v[40:43]
  s_waitcnt vmcnt(5)
  buffer_load_dwordx4 v[72:75], v11, s[12:15], s60 offen nt
  v_and_b32 v44, v250, v16
  v_and_b32 v45, v250, v17
  v_and_b32 v46, v250, v18
  v_and_b32 v47, v250, v19
  s_nop 1
  v_mfma_f32_16x16x32_bf16 v[32:35], v[44:47], v[88:91], v[32:35]
  s_waitcnt vmcnt(5)
  s_lshr_b32 s60, s61, 16
  s_mul_i32 s60, s60, 384
  buffer_load_dwordx4 v[76:79], v10, s[12:15], s60 offen nt
  v_mfma_f32_16x16x32_bf16 v[36:39], v[44:47], v[92:95], v[36:39]
  s_waitcnt vmcnt(5)
  v_readlane_b32 s61, v14, 2
  buffer_load_dwordx4 v[80:83], v10, s[12:15], s60 offen offset:128 nt
  v_mfma_f32_16x16x32_bf16 v[40:43], v[44:47], v[96:99], v[40:43]
  s_waitcnt vmcnt(5)
  buffer_load_dwordx4 v[84:87], v11, s[12:15], s60 offen nt
  v_and_b32 v240, v251, v16
  v_and_b32 v241, v251, v17
  v_and_b32 v242, v251, v18
  v_and_b32 v243, v251, v19
  ds_read_b128 v[248:251], v252 offset:16
  s_nop 0
  v_mfma_f32_16x16x32_bf16 v[32:35], v[240:243], v[100:103], v[32:35]
  s_waitcnt vmcnt(5)
  s_and_b32 s60, s61, 0xffff
  s_mul_i32 s60, s60, 384
  buffer_load_dwordx4 v[88:91], v10, s[12:15], s60 offen nt
  v_mfma_f32_16x16x32_bf16 v[36:39], v[240:243], v[104:107], v[36:39]
  s_waitcnt vmcnt(5)
  buffer_load_dwordx4 v[92:95], v10, s[12:15], s60 offen offset:128 nt
  v_mfma_f32_16x16x32_bf16 v[40:43], v[240:243], v[108:111], v[40:43]
  s_mov_b32 s62, 3
  v_add_u32 v253, 32, v252
L_dispv:
  s_waitcnt lgkmcnt(0)
  v_readfirstlane_b32 s73, v58
  s_bitcmp1_b64 s[40:41], s78
  s_cbranch_scc1 L_dutyv
  s_bitcmp1_b64 s[42:43], s78
  s_cbranch_scc1 L_procv
L_selv:
  v_readfirstlane_b32 s69, v62
  s_mul_i32 s70, s78, 128
  s_sub_i32 s69, s69, s70
  s_add_i32 s73, s73, s69
  s_add_i32 s73, s73, 80
  s_ashr_i32 s73, s73, 6
  s_max_i32 s73, s73, 0
  s_min_i32 s73, s73, 6
  s_cmp_eq_u32 s73, 1
  s_cbranch_scc1 L_v1
  s_cmp_eq_u32 s73, 2
  s_cbranch_scc1 L_v2
  s_cmp_eq_u32 s73, 3
  s_cbranch_scc1 L_v3
  s_cmp_eq_u32 s73, 4
  s_cbranch_scc1 L_v4
  s_cmp_eq_u32 s73, 5
  s_cbranch_scc1 L_v5
  s_cmp_eq_u32 s73, 6
  s_cbranch_scc1 L_v6
L_v0:
  s_waitcnt vmcnt(3)
  buffer_load_dwordx4 v[96:99], v11, s[12:15], s60 offen nt
  v_and_b32 v44, v248, v16
  v_and_b32 v45, v248, v17
  v_and_b32 v46, v248, v18
  v_and_b32 v47, v248, v19
  s_nop 1
  v_mfma_f32_16x16x32_bf16 v[32:35], v[44:47], v[64:67], v[32:35]
  s_waitcnt vmcnt(4)
  s_lshr_b32 s60, s61, 16
  s_mul_i32 s60, s60, 384
  buffer_load_dwordx4 v[100:103], v10, s[12:15], s60 offen nt
  v_mfma_f32_16x16x32_bf16 v[36:39], v[44:47], v[68:71], v[36:39]
  s_waitcnt vmcnt(3)
  v_readlane_b32 s61, v14, s62
  s_add_u32 s62, s62, 1
  buffer_load_dwordx4 v[104:107], v10, s[12:15], s60 offen offset:128 nt
  v_mfma_f32_16x16x32_bf16 v[40:43], v[44:47], v[72:75], v[40:43]
  s_waitcnt vmcnt(4)
  buffer_load_dwordx4 v[108:111], v11, s[12:15], s60 offen nt
  v_and_b32 v240, v249, v16
  v_and_b32 v241, v249, v17
  v_and_b32 v242, v249, v18
  v_and_b32 v243, v249, v19
  s_nop 1
  v_mfma_f32_16x16x32_bf16 v[32:35], v[240:243], v[76:79], v[32:35]
  s_waitcnt vmcnt(3)
  s_and_b32 s60, s61, 0xffff
  s_mul_i32 s60, s60, 384
  buffer_load_dwordx4 v[64:67], v10, s[12:15], s60 offen nt
  v_mfma_f32_16x16x32_bf16 v[36:39], v[240:243], v[80:83], v[36:39]
  s_waitcnt vmcnt(4)
  buffer_load_dwordx4 v[68:71], v10, s[12:15], s60 offen offset:128 nt
  v_mfma_f32_16x16x32_bf16 v[40:43], v[240:243], v[84:87], v[40:43]
  s_waitcnt vmcnt(3)
  buffer_load_dwordx4 v[72:75], v11, s[12:15], s60 offen nt
  v_and_b32 v44, v250, v16
  v_and_b32 v45, v250, v17
  v_and_b32 v46, v250, v18
  v_and_b32 v47, v250, v19
  s_nop 1
  v_mfma_f32_16x16x32_bf16 v[32:35], v[44:47], v[88:91], v[32:35]
  s_waitcnt vmcnt(4)
  s_lshr_b32 s60, s61, 16
  s_mul_i32 s60, s60, 384
  buffer_load_dwordx4 v[76:79], v10, s[12:15], s60 offen nt
  v_mfma_f32_16x16x32_bf16 v[36:39], v[44:47], v[92:95], v[36:39]
  s_waitcnt vmcnt(3)
  v_readlane_b32 s61, v14, s62
  s_add_u32 s62, s62, 1
  buffer_load_dwordx4 v[80:83], v10, s[12:15], s60 offen offset:128 nt
  v_mfma_f32_16x16x32_bf16 v[40:43], v[44:47], v[96:99], v[40:43]
  s_waitcnt vmcnt(4)
  buffer_load_dwordx4 v[84:87], v11, s[12:15], s60 offen nt
  v_and_b32 v240, v251, v16
  v_and_b32 v241, v251, v17
  v_and_b32 v242, v251, v18
  v_and_b32 v243, v251, v19
  ds_read_b128 v[248:251], v253
  v_add_u32 v253, 16, v253
  v_mfma_f32_16x16x32_bf16 v[32:35], v[240:243], v[100:103], v[32:35]
  ds_read_b64 v[58:59], v5 offset:13896
  ds_add_rtn_u32 v62, v57, v15 offset:13904
  s_waitcnt vmcnt(3)
  s_and_b32 s60, s61, 0xffff
  s_mul_i32 s60, s60, 384
  buffer_load_dwordx4 v[88:91], v10, s[12:15], s60 offen nt
  v_mfma_f32_16x16x32_bf16 v[36:39], v[240:243], v[104:107], v[36:39]
  s_waitcnt vmcnt(4)
  buffer_load_dwordx4 v[92:95], v10, s[12:15], s60 offen offset:128 nt
  v_mfma_f32_16x16x32_bf16 v[40:43], v[240:243], v[108:111], v[40:43]
  s_add_u32 s78, s78, 1
  s_cmp_lt_u32 s78, 38
  s_cbranch_scc1 L_dispv
  s_branch L_tailv
L_v1:
  s_waitcnt vmcnt(4)
  buffer_load_dwordx4 v[96:99], v11, s[12:15], s60 offen nt
  v_and_b32 v44, v248, v16
  v_and_b32 v45, v248, v17
  v_and_b32 v46, v248, v18
  v_and_b32 v47, v248, v19
  s_nop 1
  v_mfma_f32_16x16x32_bf16 v[32:35], v[44:47], v[64:67], v[32:35]
  s_waitcnt vmcnt(4)
  s_lshr_b32 s60, s61, 16
  s_mul_i32 s60, s60, 384
  buffer_load_dwordx4 v[100:103], v10, s[12:15], s60 offen nt
  v_mfma_f32_16x16x32_bf16 v[36:39], v[44:47], v[68:71], v[36:39]
  s_waitcnt vmcnt(4)
  v_readlane_b32 s61, v14, s62
  s_add_u32 s62, s62, 1
  buffer_load_dwordx4 v[104:107], v10, s[12:15], s60 offen offset:128 nt
  v_mfma_f32_16x16x32_bf16 v[40:43], v[44:47], v[72:75], v[40:43]
  s_waitcnt vmcnt(4)
  buffer_load_dwordx4 v[108:111], v11, s[12:15], s60 offen nt
  v_and_b32 v240, v249, v16
  v_and_b32 v241, v249, v17
  v_and_b32 v242, v249, v18
  v_and_b32 v243, v249, v19
  s_nop 1
  v_mfma_f32_16x16x32_bf16 v[32:35], v[240:243], v[76:79], v[32:35]
  s_waitcnt vmcnt(4)
  s_and_b32 s60, s61, 0xffff
  s_mul_i32 s60, s60, 384
  buffer_load_dwordx4 v[64:67], v10, s[12:15], s60 offen nt
  v_mfma_f32_16x16x32_bf16 v[36:39], v[240:243], v[80:83], v[36:39]
  s_waitcnt vmcnt(4)
  buffer_load_dwordx4 v[68:71], v10, s[12:15], s60 offen offset:128 nt
  v_mfma_f32_16x16x32_bf16 v[40:43], v[240:243], v[84:87], v[40:43]
  s_waitcnt vmcnt(4)
  buffer_load_dwordx4 v[72:75], v11, s[12:15], s60 offen nt
  v_and_b32 v44, v250, v16
  v_and_b32 v45, v250, v17
  v_and_b32 v46, v250, v18
  v_and_b32 v47, v250, v19
  s_nop 1
  v_mfma_f32_16x16x32_bf16 v[32:35], v[44:47], v[88:91], v[32:35]
  s_waitcnt vmcnt(4)
  s_lshr_b32 s60, s61, 16
  s_mul_i32 s60, s60, 384
  buffer_load_dwordx4 v[76:79], v10, s[12:15], s60 offen nt
  v_mfma_f32_16x16x32_bf16 v[36:39], v[44:47], v[92:95], v[36:39]
  s_waitcnt vmcnt(4)
  v_readlane_b32 s61, v14, s62
  s_add_u32 s62, s62, 1
  buffer_load_dwordx4 v[80:83], v10, s[12:15], s60 offen offset:128 nt
  v_mfma_f32_16x16x32_bf16 v[40:43], v[44:47], v[96:99], v[40:43]
  s_waitcnt vmcnt(4)
  buffer_load_dwordx4 v[84:87], v11, s[12:15], s60 offen nt
  v_and_b32 v240, v251, v16
  v_and_b32 v241, v251, v17
  v_and_b32 v242, v251, v18
  v_and_b32 v243, v251, v19
  ds_read_b128 v[248:251], v253
  v_add_u32 v253, 16, v253
  v_mfma_f32_16x16x32_bf16 v[32:35], v[240:243], v[100:103], v[32:35]
  ds_read_b64 v[58:59], v5 offset:13896
  ds_add_rtn_u32 v62, v57, v15 offset:13904
  s_waitcnt vmcnt(4)
  s_and_b32 s60, s61, 0xffff
  s_mul_i32 s60, s60, 384
  buffer_load_dwordx4 v[88:91], v10, s[12:15], s60 offen nt
  v_mfma_f32_16x16x32_bf16 v[36:39], v[240:243], v[104:107], v[36:39]
  s_waitcnt vmcnt(4)
  buffer_load_dwordx4 v[92:95], v10, s[12:15], s60 offen offset:128 nt
  v_mfma_f32_16x16x32_bf16 v[40:43], v[240:243], v[108:111], v[40:43]
  s_add_u32 s78, s78, 1
  s_cmp_lt_u32 s78, 38
  s_cbranch_scc1 L_dispv
  s_branch L_tailv
L_v2:
  s_waitcnt vmcnt(4)
  buffer_load_dwordx4 v[96:99], v11, s[12:15], s60 offen nt
  v_and_b32 v44, v248, v16
  v_and_b32 v45, v248, v17
  v_and_b32 v46, v248, v18
  v_and_b32 v47, v248, v19
  s_nop 1
  v_mfma_f32_16x16x32_bf16 v[32:35], v[44:47], v[64:67], v[32:35]
  s_waitcnt vmcnt(5)
  s_lshr_b32 s60, s61, 16
  s_mul_i32 s60, s60, 384
  buffer_load_dwordx4 v[100:103], v10, s[12:15], s60 offen nt
  v_mfma_f32_16x16x32_bf16 v[36:39], v[44:47], v[68:71], v[36:39]
  s_waitcnt vmcnt(4)
  v_readlane_b32 s61, v14, s62
  s_add_u32 s62, s62, 1
  buffer_load_dwordx4 v[104:107], v10, s[12:15], s60 offen offset:128 nt
  v_mfma_f32_16x16x32_bf16 v[40:43], v[44:47], v[72:75], v[40:43]
  s_waitcnt vmcnt(5)
  buffer_load_dwordx4 v[108:111], v11, s[12:15], s60 offen nt
  v_and_b32 v240, v249, v16
  v_and_b32 v241, v249, v17
  v_and_b32 v242, v249, v18
  v_and_b32 v243, v249, v19
  s_nop 1
  v_mfma_f32_16x16x32_bf16 v[32:35], v[240:243], v[76:79], v[32:35]
  s_waitcnt vmcnt(4)
  s_and_b32 s60, s61, 0xffff
  s_mul_i32 s60, s60, 384
  buffer_load_dwordx4 v[64:67], v10, s[12:15], s60 offen nt
  v_mfma_f32_16x16x32_bf16 v[36:39], v[240:243], v[80:83], v[36:39]
  s_waitcnt vmcnt(5)
  buffer_load_dwordx4 v[68:71], v10, s[12:15], s60 offen offset:128 nt
  v_mfma_f32_16x16x32_bf16 v[40:43], v[240:243], v[84:87], v[40:43]
  s_waitcnt vmcnt(4)
  buffer_load_dwordx4 v[72:75], v11, s[12:15], s60 offen nt
  v_and_b32 v44, v250, v16
  v_and_b32 v45, v250, v17
  v_and_b32 v46, v250, v18
  v_and_b32 v47, v250, v19
  s_nop 1
  v_mfma_f32_16x16x32_bf16 v[32:35], v[44:47], v[88:91], v[32:35]
  s_waitcnt vmcnt(5)
  s_lshr_b32 s60, s61, 16
  s_mul_i32 s60, s60, 384
  buffer_load_dwordx4 v[76:79], v10, s[12:15], s60 offen nt
  v_mfma_f32_16x16x32_bf16 v[36:39], v[44:47], v[92:95], v[36:39]
  s_waitcnt vmcnt(4)
  v_readlane_b32 s61, v14, s62
  s_add_u32 s62, s62, 1
  buffer_load_dwordx4 v[80:83], v10, s[12:15], s60 offen offset:128 nt
  v_mfma_f32_16x16x32_bf16 v[40:43], v[44:47], v[96:99], v[40:43]
  s_waitcnt vmcnt(5)
  buffer_load_dwordx4 v[84:87], v11, s[12:15], s60 offen nt
  v_and_b32 v240, v251, v16
  v_and_b32 v241, v251, v17
  v_and_b32 v242, v251, v18
  v_and_b32 v243, v251, v19
  ds_read_b128 v[248:251], v253
  v_add_u32 v253, 16, v253
  v_mfma_f32_16x16x32_bf16 v[32:35], v[240:243], v[100:103], v[32:35]
  ds_read_b64 v[58:59], v5 offset:13896
  ds_add_rtn_u32 v62, v57, v15 offset:13904
  s_waitcnt vmcnt(4)
  s_and_b32 s60, s61, 0xffff
  s_mul_i32 s60, s60, 384
  buffer_load_dwordx4 v[88:91], v10, s[12:15], s60 offen nt
  v_mfma_f32_16x16x32_bf16 v[36:39], v[240:243], v[104:107], v[36:39]
  s_waitcnt vmcnt(5)
  buffer_load_dwordx4 v[92:95], v10, s[12:15], s60 offen offset:128 nt
  v_mfma_f32_16x16x32_bf16 v[40:43], v[240:243], v[108:111], v[40:43]
  s_add_u32 s78, s78, 1
  s_cmp_lt_u32 s78, 38
  s_cbranch_scc1 L_dispv
  s_branch L_tailv
L_v3:
  s_waitcnt vmcnt(5)
  buffer_load_dwordx4 v[96:99], v11, s[12:15], s60 offen nt
  v_and_b32 v44, v248, v16
  v_and_b32 v45, v248, v17
  v_and_b32 v46, v248, v18
  v_and_b32 v47, v248, v19
  s_nop 1
  v_mfma_f32_16x16x32_bf16 v[32:35], v[44:47], v[64:67], v[32:35]
  s_waitcnt vmcnt(5)
  s_lshr_b32 s60, s61, 16
  s_mul_i32 s60, s60, 384
  buffer_load_dwordx4 v[100:103], v10, s[12:15], s60 offen nt
  v_mfma_f32_16x16x32_bf16 v[36:39], v[44:47], v[68:71], v[36:39]
  s_waitcnt vmcnt(5)
  v_readlane_b32 s61, v14, s62
  s_add_u32 s62, s62, 1
  buffer_load_dwordx4 v[104:107], v10, s[12:15], s60 offen offset:128 nt
  v_mfma_f32_16x16x32_bf16 v[40:43], v[44:47], v[72:75], v[40:43]
  s_waitcnt vmcnt(5)
  buffer_load_dwordx4 v[108:111], v11, s[12:15], s60 offen nt
  v_and_b32 v240, v249, v16
  v_and_b32 v241, v249, v17
  v_and_b32 v242, v249, v18
  v_and_b32 v243, v249, v19
  s_nop 1
  v_mfma_f32_16x16x32_bf16 v[32:35], v[240:243], v[76:79], v[32:35]
  s_waitcnt vmcnt(5)
  s_and_b32 s60, s61, 0xffff
  s_mul_i32 s60, s60, 384
  buffer_load_dwordx4 v[64:67], v10, s[12:15], s60 offen nt
  v_mfma_f32_16x16x32_bf16 v[36:39], v[240:243], v[80:83], v[36:39]
  s_waitcnt vmcnt(5)
  buffer_load_dwordx4 v[68:71], v10, s[12:15], s60 offen offset:128 nt
  v_mfma_f32_16x16x32_bf16 v[40:43], v[240:243], v[84:87], v[40:43]
  s_waitcnt vmcnt(5)
  buffer_load_dwordx4 v[72:75], v11, s[12:15], s60 offen nt
  v_and_b32 v44, v250, v16
  v_and_b32 v45, v250, v17
  v_and_b32 v46, v250, v18
  v_and_b32 v47, v250, v19
  s_nop 1
  v_mfma_f32_16x16x32_bf16 v[32:35], v[44:47], v[88:91], v[32:35]
  s_waitcnt vmcnt(5)
  s_lshr_b32 s60, s61, 16
  s_mul_i32 s60, s60, 384
  buffer_load_dwordx4 v[76:79], v10, s[12:15], s60 offen nt
  v_mfma_f32_16x16x32_bf16 v[36:39], v[44:47], v[92:95], v[36:39]
  s_waitcnt vmcnt(5)
  v_readlane_b32 s61, v14, s62
  s_add_u32 s62, s62, 1
  buffer_load_dwordx4 v[80:83], v10, s[12:15], s60 offen offset:128 nt
  v_mfma_f32_16x16x32_bf16 v[40:43], v[44:47], v[96:99], v[40:43]
  s_waitcnt vmcnt(5)
  buffer_load_dwordx4 v[84:87], v11, s[12:15], s60 offen nt
  v_and_b32 v240, v251, v16
  v_and_b32 v241, v251, v17
  v_and_b32 v242, v251, v18
  v_and_b32 v243, v251, v19
  ds_read_b128 v[248:251], v253
  v_add_u32 v253, 16, v253
  v_mfma_f32_16x16x32_bf16 v[32:35], v[240:243], v[100:103], v[32:35]
  ds_read_b64 v[58:59], v5 offset:13896
  ds_add_rtn_u32 v62, v57, v15 offset:13904
  s_waitcnt vmcnt(5)
  s_and_b32 s60, s61, 0xffff
  s_mul_i32 s60, s60, 384
  buffer_load_dwordx4 v[88:91], v10, s[12:15], s60 offen nt
  v_mfma_f32_16x16x32_bf16 v[36:39], v[240:243], v[104:107], v[36:39]
  s_waitcnt vmcnt(5)
  buffer_load_dwordx4 v[92:95], v10, s[12:15], s60 offen offset:128 nt
  v_mfma_f32_16x16x32_bf16 v[40:43], v[240:243], v[108:111], v[40:43]
  s_add_u32 s78, s78, 1
  s_cmp_lt_u32 s78, 38
  s_cbranch_scc1 L_dispv
  s_branch L_tailv
L_v4:
  s_waitcnt vmcnt(5)
  buffer_load_dwordx4 v[96:99], v11, s[12:15], s60 offen nt
  v_and_b32 v44, v248, v16
  v_and_b32 v45, v248, v17
  v_and_b32 v46, v248, v18
  v_and_b32 v47, v248, v19
  s_nop 1
  v_mfma_f32_16x16x32_bf16 v[32:35], v[44:47], v[64:67], v[32:35]
  s_waitcnt vmcnt(6)
  s_lshr_b32 s60, s61, 16
  s_mul_i32 s60, s60, 384
  buffer_load_dwordx4 v[100:103], v10, s[12:15], s60 offen nt
  v_mfma_f32_16x16x32_bf16 v[36:39], v[44:47], v[68:71], v[36:39]
  s_waitcnt vmcnt(5)
  v_readlane_b32 s61, v14, s62
  s_add_u32 s62, s62, 1
  buffer_load_dwordx4 v[104:107], v10, s[12:15], s60 offen offset:128 nt
  v_mfma_f32_16x16x32_bf16 v[40:43], v[44:47], v[72:75], v[40:43]
  s_waitcnt vmcnt(6)
  buffer_load_dwordx4 v[108:111], v11, s[12:15], s60 offen nt
  v_and_b32 v240, v249, v16
  v_and_b32 v241, v249, v17
  v_and_b32 v242, v249, v18
  v_and_b32 v243, v249, v19
  s_nop 1
  v_mfma_f32_16x16x32_bf16 v[32:35], v[240:243], v[76:79], v[32:35]
  s_waitcnt vmcnt(5)
  s_and_b32 s60, s61, 0xffff
  s_mul_i32 s60, s60, 384
  buffer_load_dwordx4 v[64:67], v10, s[12:15], s60 offen nt
  v_mfma_f32_16x16x32_bf16 v[36:39], v[240:243], v[80:83], v[36:39]
  s_waitcnt vmcnt(6)
  buffer_load_dwordx4 v[68:71], v10, s[12:15], s60 offen offset:128 nt
  v_mfma_f32_16x16x32_bf16 v[40:43], v[240:243], v[84:87], v[40:43]
  s_waitcnt vmcnt(5)
  buffer_load_dwordx4 v[72:75], v11, s[12:15], s60 offen nt
  v_and_b32 v44, v250, v16
  v_and_b32 v45, v250, v17
  v_and_b32 v46, v250, v18
  v_and_b32 v47, v250, v19
  s_nop 1
  v_mfma_f32_16x16x32_bf16 v[32:35], v[44:47], v[88:91], v[32:35]
  s_waitcnt vmcnt(6)
  s_lshr_b32 s60, s61, 16
  s_mul_i32 s60, s60, 384
  buffer_load_dwordx4 v[76:79], v10, s[12:15], s60 offen nt
  v_mfma_f32_16x16x32_bf16 v[36:39], v[44:47], v[92:95], v[36:39]
  s_waitcnt vmcnt(5)
  v_readlane_b32 s61, v14, s62
  s_add_u32 s62, s62, 1
  buffer_load_dwordx4 v[80:83], v10, s[12:15], s60 offen offset:128 nt
  v_mfma_f32_16x16x32_bf16 v[40:43], v[44:47], v[96:99], v[40:43]
  s_waitcnt vmcnt(6)
  buffer_load_dwordx4 v[84:87], v11, s[12:15], s60 offen nt
  v_and_b32 v240, v251, v16
  v_and_b32 v241, v251, v17
  v_and_b32 v242, v251, v18
  v_and_b32 v243, v251, v19
  ds_read_b128 v[248:251], v253
  v_add_u32 v253, 16, v253
  v_mfma_f32_16x16x32_bf16 v[32:35], v[240:243], v[100:103], v[32:35]
  ds_read_b64 v[58:59], v5 offset:13896
  ds_add_rtn_u32 v62, v57, v15 offset:13904
  s_waitcnt vmcnt(5)
  s_and_b32 s60, s61, 0xffff
  s_mul_i32 s60, s60, 384
  buffer_load_dwordx4 v[88:91], v10, s[12:15], s60 offen nt
  v_mfma_f32_16x16x32_bf16 v[36:39], v[240:243], v[104:107], v[36:39]
  s_waitcnt vmcnt(6)
  buffer_load_dwordx4 v[92:95], v10, s[12:15], s60 offen offset:128 nt
  v_mfma_f32_16x16x32_bf16 v[40:43], v[240:243], v[108:111], v[40:43]
  s_add_u32 s78, s78, 1
  s_cmp_lt_u32 s78, 38
  s_cbranch_scc1 L_dispv
  s_branch L_tailv
L_v5:
  s_waitcnt vmcnt(6)
  buffer_load_dwordx4 v[96:99], v11, s[12:15], s60 offen nt
  v_and_b32 v44, v248, v16
  v_and_b32 v45, v248, v17
  v_and_b32 v46, v248, v18
  v_and_b32 v47, v248, v19
  s_nop 1
  v_mfma_f32_16x16x32_bf16 v[32:35], v[44:47], v[64:67], v[32:35]
  s_waitcnt vmcnt(6)
  s_lshr_b32 s60, s61, 16
  s_mul_i32 s60, s60, 384
  buffer_load_dwordx4 v[100:103], v10, s[12:15], s60 offen nt
  v_mfma_f32_16x16x32_bf16 v[36:39], v[44:47], v[68:71], v[36:39]
  s_waitcnt vmcnt(6)
  v_readlane_b32 s61, v14, s62
  s_add_u32 s62, s62, 1
  buffer_load_dwordx4 v[104:107], v10, s[12:15], s60 offen offset:128 nt
  v_mfma_f32_16x16x32_bf16 v[40:43], v[44:47], v[72:75], v[40:43]
  s_waitcnt vmcnt(6)
  buffer_load_dwordx4 v[108:111], v11, s[12:15], s60 offen nt
  v_and_b32 v240, v249, v16
  v_and_b32 v241, v249, v17
  v_and_b32 v242, v249, v18
  v_and_b32 v243, v249, v19
  s_nop 1
  v_mfma_f32_16x16x32_bf16 v[32:35], v[240:243], v[76:79], v[32:35]
  s_waitcnt vmcnt(6)
  s_and_b32 s60, s61, 0xffff
  s_mul_i32 s60, s60, 384
  buffer_load_dwordx4 v[64:67], v10, s[12:15], s60 offen nt
  v_mfma_f32_16x16x32_bf16 v[36:39], v[240:243], v[80:83], v[36:39]
  s_waitcnt vmcnt(6)
  buffer_load_dwordx4 v[68:71], v10, s[12:15], s60 offen offset:128 nt
  v_mfma_f32_16x16x32_bf16 v[40:43], v[240:243], v[84:87], v[40:43]
  s_waitcnt vmcnt(6)
  buffer_load_dwordx4 v[72:75], v11, s[12:15], s60 offen nt
  v_and_b32 v44, v250, v16
  v_and_b32 v45, v250, v17
  v_and_b32 v46, v250, v18
  v_and_b32 v47, v250, v19
  s_nop 1
  v_mfma_f32_16x16x32_bf16 v[32:35], v[44:47], v[88:91], v[32:35]
  s_waitcnt vmcnt(6)
  s_lshr_b32 s60, s61, 16
  s_mul_i32 s60, s60, 384
  buffer_load_dwordx4 v[76:79], v10, s[12:15], s60 offen nt
  v_mfma_f32_16x16x32_bf16 v[36:39], v[44:47], v[92:95], v[36:39]
  s_waitcnt vmcnt(6)
  v_readlane_b32 s61, v14, s62
  s_add_u32 s62, s62, 1
  buffer_load_dwordx4 v[80:83], v10, s[12:15], s60 offen offset:128 nt
  v_mfma_f32_16x16x32_bf16 v[40:43], v[44:47], v[96:99], v[40:43]
  s_waitcnt vmcnt(6)
  buffer_load_dwordx4 v[84:87], v11, s[12:15], s60 offen nt
  v_and_b32 v240, v251, v16
  v_and_b32 v241, v251, v17
  v_and_b32 v242, v251, v18
  v_and_b32 v243, v251, v19
  ds_read_b128 v[248:251], v253
  v_add_u32 v253, 16, v253
  v_mfma_f32_16x16x32_bf16 v[32:35], v[240:243], v[100:103], v[32:35]
  ds_read_b64 v[58:59], v5 offset:13896
  ds_add_rtn_u32 v62, v57, v15 offset:13904
  s_waitcnt vmcnt(6)
  s_and_b32 s60, s61, 0xffff
  s_mul_i32 s60, s60, 384
  buffer_load_dwordx4 v[88:91], v10, s[12:15], s60 offen nt
  v_mfma_f32_16x16x32_bf16 v[36:39], v[240:243], v[104:107], v[36:39]
  s_waitcnt vmcnt(6)
  buffer_load_dwordx4 v[92:95], v10, s[12:15], s60 offen offset:128 nt
  v_mfma_f32_16x16x32_bf16 v[40:43], v[240:243], v[108:111], v[40:43]
  s_add_u32 s78, s78, 1
  s_cmp_lt_u32 s78, 38
  s_cbranch_scc1 L_dispv
  s_branch L_tailv
L_v6:
  s_waitcnt vmcnt(7)
  buffer_load_dwordx4 v[96:99], v11, s[12:15], s60 offen nt
  v_and_b32 v44, v248, v16
  v_and_b32 v45, v248, v17
  v_and_b32 v46, v248, v18
  v_and_b32 v47, v248, v19
  s_nop 1
  v_mfma_f32_16x16x32_bf16 v[32:35], v[44:47], v[64:67], v[32:35]
  s_waitcnt vmcnt(7)
  s_lshr_b32 s60, s61, 16
  s_mul_i32 s60, s60, 384
  buffer_load_dwordx4 v[100:103], v10, s[12:15], s60 offen nt
  v_mfma_f32_16x16x32_bf16 v[36:39], v[44:47], v[68:71], v[36:39]
  s_waitcnt vmcnt(7)
  v_readlane_b32 s61, v14, s62
  s_add_u32 s62, s62, 1
  buffer_load_dwordx4 v[104:107], v10, s[12:15], s60 offen offset:128 nt
  v_mfma_f32_16x16x32_bf16 v[40:43], v[44:47], v[72:75], v[40:43]
  s_waitcnt vmcnt(7)
  buffer_load_dwordx4 v[108:111], v11, s[12:15], s60 offen nt
  v_and_b32 v240, v249, v16
  v_and_b32 v241, v249, v17
  v_and_b32 v242, v249, v18
  v_and_b32 v243, v249, v19
  s_nop 1
  v_mfma_f32_16x16x32_bf16 v[32:35], v[240:243], v[76:79], v[32:35]
  s_waitcnt vmcnt(7)
  s_and_b32 s60, s61, 0xffff
  s_mul_i32 s60, s60, 384
  buffer_load_dwordx4 v[64:67], v10, s[12:15], s60 offen nt
  v_mfma_f32_16x16x32_bf16 v[36:39], v[240:243], v[80:83], v[36:39]
  s_waitcnt vmcnt(7)
  buffer_load_dwordx4 v[68:71], v10, s[12:15], s60 offen offset:128 nt
  v_mfma_f32_16x16x32_bf16 v[40:43], v[240:243], v[84:87], v[40:43]
  s_waitcnt vmcnt(7)
  buffer_load_dwordx4 v[72:75], v11, s[12:15], s60 offen nt
  v_and_b32 v44, v250, v16
  v_and_b32 v45, v250, v17
  v_and_b32 v46, v250, v18
  v_and_b32 v47, v250, v19
  s_nop 1
  v_mfma_f32_16x16x32_bf16 v[32:35], v[44:47], v[88:91], v[32:35]
  s_waitcnt vmcnt(7)
  s_lshr_b32 s60, s61, 16
  s_mul_i32 s60, s60, 384
  buffer_load_dwordx4 v[76:79], v10, s[12:15], s60 offen nt
  v_mfma_f32_16x16x32_bf16 v[36:39], v[44:47], v[92:95], v[36:39]
  s_waitcnt vmcnt(7)
  v_readlane_b32 s61, v14, s62
  s_add_u32 s62, s62, 1
  buffer_load_dwordx4 v[80:83], v10, s[12:15], s60 offen offset:128 nt
  v_mfma_f32_16x16x32_bf16 v[40:43], v[44:47], v[96:99], v[40:43]
  s_waitcnt vmcnt(7)
  buffer_load_dwordx4 v[84:87], v11, s[12:15], s60 offen nt
  v_and_b32 v240, v251, v16
  v_and_b32 v241, v251, v17
  v_and_b32 v242, v251, v18
  v_and_b32 v243, v251, v19
  ds_read_b128 v[248:251], v253
  v_add_u32 v253, 16, v253
  v_mfma_f32_16x16x32_bf16 v[32:35], v[240:243], v[100:103], v[32:35]
  ds_read_b64 v[58:59], v5 offset:13896
  ds_add_rtn_u32 v62, v57, v15 offset:13904
  s_waitcnt vmcnt(7)
  s_and_b32 s60, s61, 0xffff
  s_mul_i32 s60, s60, 384
  buffer_load_dwordx4 v[88:91], v10, s[12:15], s60 offen nt
  v_mfma_f32_16x16x32_bf16 v[36:39], v[240:243], v[104:107], v[36:39]
  s_waitcnt vmcnt(7)
  buffer_load_dwordx4 v[92:95], v10, s[12:15], s60 offen offset:128 nt
  v_mfma_f32_16x16x32_bf16 v[40:43], v[240:243], v[108:111], v[40:43]
  s_add_u32 s78, s78, 1
  s_cmp_lt_u32 s78, 38
  s_cbranch_scc1 L_dispv
L_tailv:
L_mw:
  ds_read_b32 v6, v5 offset:13856
  ds_read_b128 v[112:115], v5 offset:13824
  ds_read_b128 v[116:119], v5 offset:13840
  s_waitcnt lgkmcnt(0)
  v_readfirstlane_b32 s69, v6
  s_cmp_lg_u32 s69, 4
  s_cbranch_scc1 L_mw
  s_waitcnt vmcnt(7)
  buffer_load_dwordx4 v[96:99], v11, s[12:15], s60 offen nt
  s_waitcnt lgkmcnt(0)
  v_and_b32 v44, v248, v16
  v_and_b32 v45, v248, v17
  v_and_b32 v46, v248, v18
  v_and_b32 v47, v248, v19
  s_nop 1
  v_mfma_f32_16x16x32_bf16 v[32:35], v[44:47], v[64:67], v[32:35]
  v_min_f32 v49, v112, v114
  v_min3_f32 v49, v116, v118, v49
  v_sub_f32 v112, v49, v112
  v_exp_f32 v112, v112
  v_sub_f32 v114, v49, v114
  v_exp_f32 v114, v114
  v_sub_f32 v116, v49, v116
  v_exp_f32 v116, v116
  v_sub_f32 v118, v49, v118
  v_exp_f32 v118, v118
  v_sub_f32 v254, v49, v52
  v_exp_f32 v254, v254
  v_mul_f32 v51, v112, v113
  v_fma_f32 v51, v114, v115, v51
  v_fma_f32 v51, v116, v117, v51
  v_fma_f32 v51, v118, v119, v51
  v_rcp_f32 v51, v51
  s_nop 0
  v_mul_f32 v254, v254, v51
  s_waitcnt vmcnt(7)
  s_lshr_b32 s60, s61, 16
  s_mul_i32 s60, s60, 384
  buffer_load_dwordx4 v[100:103], v10, s[12:15], s60 offen nt
  v_mfma_f32_16x16x32_bf16 v[36:39], v[44:47], v[68:71], v[36:39]
  v_lshlrev_b32 v57, 8, v3
  v_add_u32 v57, v56, v57
  v_lshl_add_u32 v58, v9, 1, v56
  v_and_b32 v59, 15, v0
  v_min_u32 v59, 11, v59
  v_mul_u32_u24 v60, 12, v4
  v_add_u32 v59, v59, v60
  s_mul_i32 s69, s56, 192
  v_lshlrev_b32 v59, 2, v59
  v_add_u32 v59, s69, v59
  v_lshlrev_b32 v60, 1, v1
  v_bfe_u32 v61, v0, 4, 1
  v_lshl_add_u32 v60, v61, 4, v60
  v_lshl_add_u32 v60, v3, 8, v60
  s_mul_i32 s69, s56, 2560
  v_add_u32 v60, s69, v60
  s_lshl_b32 s69, s56, 10
  v_lshlrev_b32 v61, 4, v0
  v_add_u32 v61, s69, v61
  v_lshlrev_b32 v61, 4, v0
  s_mul_i32 s69, s56, 640
  v_add_u32 v62, s69, v61
  s_mul_i32 s69, s56, 5120
  v_add_u32 v15, s69, v61
  s_waitcnt vmcnt(7)
  buffer_load_dwordx4 v[104:107], v10, s[12:15], s60 offen offset:128 nt
  v_mfma_f32_16x16x32_bf16 v[40:43], v[44:47], v[72:75], v[40:43]
  s_waitcnt vmcnt(7)
  buffer_load_dwordx4 v[108:111], v11, s[12:15], s60 offen nt
  v_and_b32 v240, v249, v16
  v_and_b32 v241, v249, v17
  v_and_b32 v242, v249, v18
  v_and_b32 v243, v249, v19
  s_nop 1
  v_mfma_f32_16x16x32_bf16 v[32:35], v[240:243], v[76:79], v[32:35]
  s_cmp_lg_u32 s56, 0
  s_cbranch_scc1 L_notk
  s_lshl_b32 s69, s57, 5
  v_mov_b32 v63, 1
  s_mov_b64 exec, 1
  buffer_atomic_add v63, v5, s[36:39], s69 offen sc0 sc1
  s_mov_b64 exec, -1
L_notk:
  s_waitcnt vmcnt(7)
  v_mfma_f32_16x16x32_bf16 v[36:39], v[240:243], v[80:83], v[36:39]
  s_waitcnt vmcnt(6)
  v_mfma_f32_16x16x32_bf16 v[40:43], v[240:243], v[84:87], v[40:43]
  s_waitcnt vmcnt(5)
  v_and_b32 v44, v250, v16
  v_and_b32 v45, v250, v17
  v_and_b32 v46, v250, v18
  v_and_b32 v47, v250, v19
  s_nop 1
  v_mfma_f32_16x16x32_bf16 v[32:35], v[44:47], v[88:91], v[32:35]
  s_waitcnt vmcnt(4)
  v_mfma_f32_16x16x32_bf16 v[36:39], v[44:47], v[92:95], v[36:39]
  s_waitcnt vmcnt(3)
  v_mfma_f32_16x16x32_bf16 v[40:43], v[44:47], v[96:99], v[40:43]
  s_waitcnt vmcnt(2)
  v_and_b32 v240, v251, v16
  v_and_b32 v241, v251, v17
  v_and_b32 v242, v251, v18
  v_and_b32 v243, v251, v19
  s_nop 1
  v_mfma_f32_16x16x32_bf16 v[32:35], v[240:243], v[100:103], v[32:35]
  s_waitcnt vmcnt(1)
  v_mfma_f32_16x16x32_bf16 v[36:39], v[240:243], v[104:107], v[36:39]
  s_waitcnt vmcnt(0)
  v_mfma_f32_16x16x32_bf16 v[40:43], v[240:243], v[108:111], v[40:43]
  s_mov_b32 exec_lo, 0x00ff00ff
  s_mov_b32 exec_hi, 0xff00ff00
  s_nop 1
  v_mul_f32 v32, v254, v32
  v_mul_f32 v33, v254, v33
  v_mul_f32 v34, v254, v34
  v_mul_f32 v35, v254, v35
  ds_write_b128 v57, v[32:35] offset:7680
  v_mul_f32 v36, v254, v36
  v_mul_f32 v37, v254, v37
  v_mul_f32 v38, v254, v38
  v_mul_f32 v39, v254, v39
  ds_write_b128 v57, v[36:39] offset:7936
  v_mul_f32 v40, v254, v40
  v_mul_f32 v41, v254, v41
  v_mul_f32 v42, v254, v42
  v_mul_f32 v43, v254, v43
  ds_write_b128 v58, v[40:43] offset:7680
  s_cmp_eq_u32 s56, 0
  s_cselect_b64 exec, 1, 0
  ds_write_b32 v5, v63 offset:13888
  s_mov_b64 exec, -1
  s_waitcnt lgkmcnt(0)
  s_barrier
  ds_read_b32 v112, v59 offset:7680
  ds_read_b32 v113, v59 offset:8448
  ds_read_b32 v114, v59 offset:9216
  ds_read_b32 v115, v59 offset:9984
  ds_read_b32 v116, v59 offset:10752
  ds_read_b32 v117, v59 offset:11520
  ds_read_b32 v118, v59 offset:12288
  ds_read_b32 v119, v59 offset:13056
  ds_read_b32 v63, v5 offset:13888
  s_waitcnt lgkmcnt(0)
  v_add_f32 v112, v112, v116
  v_add_f32 v113, v113, v117
  v_add_f32 v114, v114, v118
  v_add_f32 v115, v115, v119
  v_add_f32 v112, v112, v114
  v_add_f32 v113, v113, v115
  v_add_f32 v112, v112, v113
  v_cvt_pk_bf16_f32 v48, v112, v112
  s_nop 1
  v_and_b32_dpp v44, v48, v16 row_newbcast:0 row_mask:0xf bank_mask:0xf
  v_and_b32_dpp v45, v48, v17 row_newbcast:0 row_mask:0xf bank_mask:0xf
  v_and_b32_dpp v46, v48, v18 row_newbcast:0 row_mask:0xf bank_mask:0xf
  v_and_b32_dpp v47, v48, v19 row_newbcast:0 row_mask:0xf bank_mask:0xf
  s_nop 1
  v_mfma_f32_16x16x32_bf16 v[64:67], v[44:47], a[216:219], 0
  v_and_b32_dpp v240, v48, v16 row_newbcast:1 row_mask:0xf bank_mask:0xf
  v_mfma_f32_16x16x32_bf16 v[68:71], v[44:47], a[220:223], 0
  v_and_b32_dpp v241, v48, v17 row_newbcast:1 row_mask:0xf bank_mask:0xf
  v_mfma_f32_16x16x32_bf16 v[72:75], v[44:47], a[224:227], 0
  v_and_b32_dpp v242, v48, v18 row_newbcast:1 row_mask:0xf bank_mask:0xf
  v_mfma_f32_16x16x32_bf16 v[76:79], v[44:47], a[228:231], 0
  v_and_b32_dpp v243, v48, v19 row_newbcast:1 row_mask:0xf bank_mask:0xf
  v_mfma_f32_16x16x32_bf16 v[80:83], v[44:47], a[232:235], 0
  s_nop 0
  v_mfma_f32_16x16x32_bf16 v[64:67], v[240:243], a[236:239], v[64:67]
  v_and_b32_dpp v32, v48, v16 row_newbcast:2 row_mask:0xf bank_mask:0xf
  v_mfma_f32_16x16x32_bf16 v[68:71], v[240:243], a[0:3], v[68:71]
  v_and_b32_dpp v33, v48, v17 row_newbcast:2 row_mask:0xf bank_mask:0xf
  v_mfma_f32_16x16x32_bf16 v[72:75], v[240:243], a[4:7], v[72:75]
  v_and_b32_dpp v34, v48, v18 row_newbcast:2 row_mask:0xf bank_mask:0xf
  v_mfma_f32_16x16x32_bf16 v[76:79], v[240:243], a[8:11], v[76:79]
  v_and_b32_dpp v35, v48, v19 row_newbcast:2 row_mask:0xf bank_mask:0xf
  v_mfma_f32_16x16x32_bf16 v[80:83], v[240:243], a[12:15], v[80:83]
  s_nop 0
  v_mfma_f32_16x16x32_bf16 v[64:67], v[32:35], a[16:19], v[64:67]
  v_and_b32_dpp v44, v48, v16 row_newbcast:3 row_mask:0xf bank_mask:0xf
  v_mfma_f32_16x16x32_bf16 v[68:71], v[32:35], a[20:23], v[68:71]
  v_and_b32_dpp v45, v48, v17 row_newbcast:3 row_mask:0xf bank_mask:0xf
  v_mfma_f32_16x16x32_bf16 v[72:75], v[32:35], a[24:27], v[72:75]
  v_and_b32_dpp v46, v48, v18 row_newbcast:3 row_mask:0xf bank_mask:0xf
  v_mfma_f32_16x16x32_bf16 v[76:79], v[32:35], a[28:31], v[76:79]
  v_and_b32_dpp v47, v48, v19 row_newbcast:3 row_mask:0xf bank_mask:0xf
  v_mfma_f32_16x16x32_bf16 v[80:83], v[32:35], a[32:35], v[80:83]
  s_nop 0
  v_mfma_f32_16x16x32_bf16 v[64:67], v[44:47], a[36:39], v[64:67]
  v_and_b32_dpp v240, v48, v16 row_newbcast:4 row_mask:0xf bank_mask:0xf
  v_mfma_f32_16x16x32_bf16 v[68:71], v[44:47], a[40:43], v[68:71]
  v_and_b32_dpp v241, v48, v17 row_newbcast:4 row_mask:0xf bank_mask:0xf
  v_mfma_f32_16x16x32_bf16 v[72:75], v[44:47], a[44:47], v[72:75]
  v_and_b32_dpp v242, v48, v18 row_newbcast:4 row_mask:0xf bank_mask:0xf
  v_mfma_f32_16x16x32_bf16 v[76:79], v[44:47], a[48:51], v[76:79]
  v_and_b32_dpp v243, v48, v19 row_newbcast:4 row_mask:0xf bank_mask:0xf
  v_mfma_f32_16x16x32_bf16 v[80:83], v[44:47], a[52:55], v[80:83]
  s_nop 0
  v_mfma_f32_16x16x32_bf16 v[64:67], v[240:243], a[56:59], v[64:67]
  v_and_b32_dpp v32, v48, v16 row_newbcast:5 row_mask:0xf bank_mask:0xf
  v_mfma_f32_16x16x32_bf16 v[68:71], v[240:243], a[60:63], v[68:71]
  v_and_b32_dpp v33, v48, v17 row_newbcast:5 row_mask:0xf bank_mask:0xf
  v_mfma_f32_16x16x32_bf16 v[72:75], v[240:243], a[64:67], v[72:75]
  v_and_b32_dpp v34, v48, v18 row_newbcast:5 row_mask:0xf bank_mask:0xf
  v_mfma_f32_16x16x32_bf16 v[76:79], v[240:243], a[68:71], v[76:79]
  v_and_b32_dpp v35, v48, v19 row_newbcast:5 row_mask:0xf bank_mask:0xf
  v_mfma_f32_16x16x32_bf16 v[80:83], v[240:243], a[72:75], v[80:83]
  s_nop 0
  v_mfma_f32_16x16x32_bf16 v[64:67], v[32:35], a[76:79], v[64:67]
  v_and_b32_dpp v44, v48, v16 row_newbcast:6 row_mask:0xf bank_mask:0xf
  v_mfma_f32_16x16x32_bf16 v[68:71], v[32:35], a[80:83], v[68:71]
  v_and_b32_dpp v45, v48, v17 row_newbcast:6 row_mask:0xf bank_mask:0xf
  v_mfma_f32_16x16x32_bf16 v[72:75], v[32:35], a[84:87], v[72:75]
  v_and_b32_dpp v46, v48, v18 row_newbcast:6 row_mask:0xf bank_mask:0xf
  v_mfma_f32_16x16x32_bf16 v[76:79], v[32:35], a[88:91], v[76:79]
  v_and_b32_dpp v47, v48, v19 row_newbcast:6 row_mask:0xf bank_mask:0xf
  v_mfma_f32_16x16x32_bf16 v[80:83], v[32:35], a[92:95], v[80:83]
  s_nop 0
  v_mfma_f32_16x16x32_bf16 v[64:67], v[44:47], a[96:99], v[64:67]
  v_and_b32_dpp v240, v48, v16 row_newbcast:7 row_mask:0xf bank_mask:0xf
  v_mfma_f32_16x16x32_bf16 v[68:71], v[44:47], a[100:103], v[68:71]
  v_and_b32_dpp v241, v48, v17 row_newbcast:7 row_mask:0xf bank_mask:0xf
  v_mfma_f32_16x16x32_bf16 v[72:75], v[44:47], a[104:107], v[72:75]
  v_and_b32_dpp v242, v48, v18 row_newbcast:7 row_mask:0xf bank_mask:0xf
  v_mfma_f32_16x16x32_bf16 v[76:79], v[44:47], a[108:111], v[76:79]
  v_and_b32_dpp v243, v48, v19 row_newbcast:7 row_mask:0xf bank_mask:0xf
  v_mfma_f32_16x16x32_bf16 v[80:83], v[44:47], a[112:115], v[80:83]
  s_nop 0
  v_mfma_f32_16x16x32_bf16 v[64:67], v[240:243], a[116:119], v[64:67]
  v_and_b32_dpp v32, v48, v16 row_newbcast:8 row_mask:0xf bank_mask:0xf
  v_mfma_f32_16x16x32_bf16 v[68:71], v[240:243], a[120:123], v[68:71]
  v_and_b32_dpp v33, v48, v17 row_newbcast:8 row_mask:0xf bank_mask:0xf
  v_mfma_f32_16x16x32_bf16 v[72:75], v[240:243], a[124:127], v[72:75]
  v_and_b32_dpp v34, v48, v18 row_newbcast:8 row_mask:0xf bank_mask:0xf
  v_mfma_f32_16x16x32_bf16 v[76:79], v[240:243], a[128:131], v[76:79]
  v_and_b32_dpp v35, v48, v19 row_newbcast:8 row_mask:0xf bank_mask:0xf
  v_mfma_f32_16x16x32_bf16 v[80:83], v[240:243], a[132:135], v[80:83]
  s_nop 0
  v_mfma_f32_16x16x32_bf16 v[64:67], v[32:35], a[136:139], v[64:67]
  v_and_b32_dpp v44, v48, v16 row_newbcast:9 row_mask:0xf bank_mask:0xf
  v_mfma_f32_16x16x32_bf16 v[68:71], v[32:35], a[140:143], v[68:71]
  v_and_b32_dpp v45, v48, v17 row_newbcast:9 row_mask:0xf bank_mask:0xf
  v_mfma_f32_16x16x32_bf16 v[72:75], v[32:35], a[144:147], v[72:75]
  v_and_b32_dpp v46, v48, v18 row_newbcast:9 row_mask:0xf bank_mask:0xf
  v_mfma_f32_16x16x32_bf16 v[76:79], v[32:35], a[148:151], v[76:79]
  v_and_b32_dpp v47, v48, v19 row_newbcast:9 row_mask:0xf bank_mask:0xf
  v_mfma_f32_16x16x32_bf16 v[80:83], v[32:35], a[152:155], v[80:83]
  s_nop 0
  v_mfma_f32_16x16x32_bf16 v[64:67], v[44:47], a[156:159], v[64:67]
  v_and_b32_dpp v240, v48, v16 row_newbcast:10 row_mask:0xf bank_mask:0xf
  v_mfma_f32_16x16x32_bf16 v[68:71], v[44:47], a[160:163], v[68:71]
  v_and_b32_dpp v241, v48, v17 row_newbcast:10 row_mask:0xf bank_mask:0xf
  v_mfma_f32_16x16x32_bf16 v[72:75], v[44:47], a[164:167], v[72:75]
  v_and_b32_dpp v242, v48, v18 row_newbcast:10 row_mask:0xf bank_mask:0xf
  v_mfma_f32_16x16x32_bf16 v[76:79], v[44:47], a[168:171], v[76:79]
  v_and_b32_dpp v243, v48, v19 row_newbcast:10 row_mask:0xf bank_mask:0xf
  v_mfma_f32_16x16x32_bf16 v[80:83], v[44:47], a[172:175], v[80:83]
  s_nop 0
  v_mfma_f32_16x16x32_bf16 v[64:67], v[240:243], a[176:179], v[64:67]
  v_and_b32_dpp v32, v48, v16 row_newbcast:11 row_mask:0xf bank_mask:0xf
  v_mfma_f32_16x16x32_bf16 v[68:71], v[240:243], a[180:183], v[68:71]
  v_and_b32_dpp v33, v48, v17 row_newbcast:11 row_mask:0xf bank_mask:0xf
  v_mfma_f32_16x16x32_bf16 v[72:75], v[240:243], a[184:187], v[72:75]
  v_and_b32_dpp v34, v48, v18 row_newbcast:11 row_mask:0xf bank_mask:0xf
  v_mfma_f32_16x16x32_bf16 v[76:79], v[240:243], a[188:191], v[76:79]
  v_and_b32_dpp v35, v48, v19 row_newbcast:11 row_mask:0xf bank_mask:0xf
  v_mfma_f32_16x16x32_bf16 v[80:83], v[240:243], a[192:195], v[80:83]
  s_nop 0
  v_mfma_f32_16x16x32_bf16 v[64:67], v[32:35], a[196:199], v[64:67]
  v_mfma_f32_16x16x32_bf16 v[68:71], v[32:35], a[200:203], v[68:71]
  v_mfma_f32_16x16x32_bf16 v[72:75], v[32:35], a[204:207], v[72:75]
  v_mfma_f32_16x16x32_bf16 v[76:79], v[32:35], a[208:211], v[76:79]
  v_mfma_f32_16x16x32_bf16 v[80:83], v[32:35], a[212:215], v[80:83]
  s_mov_b32 exec_hi, 0
  s_nop 2
  ds_write_b128 v60, v[64:67] offset:31072
  ds_write_b128 v60, v[68:71] offset:31584
  ds_write_b128 v60, v[72:75] offset:32096
  ds_write_b128 v60, v[76:79] offset:32608
  ds_write_b128 v60, v[80:83] offset:33120
  s_mov_b64 exec, -1
  s_waitcnt lgkmcnt(0)
  s_barrier
  ds_read_b128 v[112:115], v62 offset:31072
  ds_read_b128 v[116:119], v62 offset:33632
  ds_read_b128 v[120:123], v62 offset:36192
  ds_read_b128 v[124:127], v62 offset:38752
  v_readfirstlane_b32 s69, v63
  s_mul_i32 s60, s56, 20480
  s_add_u32 s74, s60, 4096
  s_add_u32 s75, s60, 8192
  s_add_u32 s76, s60, 12288
  s_add_u32 s77, s60, 16384
  s_mov_b32 exec_hi, 0xff
  s_waitcnt lgkmcnt(0)
  v_add_f32 v112, v112, v116
  v_add_f32 v120, v120, v124
  v_add_f32 v113, v113, v117
  v_add_f32 v121, v121, v125
  v_add_f32 v114, v114, v118
  v_add_f32 v122, v122, v126
  v_add_f32 v115, v115, v119
  v_add_f32 v123, v123, v127
  v_add_f32 v112, v112, v120
  v_add_f32 v113, v113, v121
  v_add_f32 v114, v114, v122
  v_add_f32 v115, v115, v123
  v_min_u32 v88, -2, v112
  v_min_u32 v89, -2, v113
  v_min_u32 v90, -2, v114
  v_min_u32 v91, -2, v115
  buffer_store_dwordx4 v[88:91], v61, s[28:31], s95 offen sc1
  s_mov_b32 exec_hi, -1
  s_cmp_lg_u32 s69, 31
  s_cbranch_scc1 L_fin
  s_mov_b32 s78, 4096
L_poll:
  buffer_load_dwordx4 v[112:115], v61, s[28:31], s60 offen sc1
  buffer_load_dwordx4 v[116:119], v61, s[28:31], s60 offen offset:1024 sc1
  buffer_load_dwordx4 v[120:123], v61, s[28:31], s60 offen offset:2048 sc1
  buffer_load_dwordx4 v[124:127], v61, s[28:31], s60 offen offset:3072 sc1
  buffer_load_dwordx4 v[128:131], v61, s[28:31], s74 offen sc1
  buffer_load_dwordx4 v[132:135], v61, s[28:31], s74 offen offset:1024 sc1
  buffer_load_dwordx4 v[136:139], v61, s[28:31], s74 offen offset:2048 sc1
  buffer_load_dwordx4 v[140:143], v61, s[28:31], s74 offen offset:3072 sc1
  buffer_load_dwordx4 v[144:147], v61, s[28:31], s75 offen sc1
  buffer_load_dwordx4 v[148:151], v61, s[28:31], s75 offen offset:1024 sc1
  buffer_load_dwordx4 v[152:155], v61, s[28:31], s75 offen offset:2048 sc1
  buffer_load_dwordx4 v[156:159], v61, s[28:31], s75 offen offset:3072 sc1
  buffer_load_dwordx4 v[160:163], v61, s[28:31], s76 offen sc1
  buffer_load_dwordx4 v[164:167], v61, s[28:31], s76 offen offset:1024 sc1
  buffer_load_dwordx4 v[168:171], v61, s[28:31], s76 offen offset:2048 sc1
  buffer_load_dwordx4 v[172:175], v61, s[28:31], s76 offen offset:3072 sc1
  buffer_load_dwordx4 v[176:179], v61, s[28:31], s77 offen sc1
  buffer_load_dwordx4 v[180:183], v61, s[28:31], s77 offen offset:1024 sc1
  buffer_load_dwordx4 v[184:187], v61, s[28:31], s77 offen offset:2048 sc1
  buffer_load_dwordx4 v[188:191], v61, s[28:31], s77 offen offset:3072 sc1
  s_waitcnt vmcnt(14)
  v_add_f32 v192, v112, v132
  v_add_f32 v193, v113, v133
  v_add_f32 v194, v114, v134
  v_add_f32 v195, v115, v135
  s_waitcnt vmcnt(13)
  v_add_f32 v196, v116, v136
  v_add_f32 v197, v117, v137
  v_add_f32 v198, v118, v138
  v_add_f32 v199, v119, v139
  s_waitcnt vmcnt(12)
  v_add_f32 v200, v120, v140
  v_add_f32 v201, v121, v141
  v_add_f32 v202, v122, v142
  v_add_f32 v203, v123, v143
  s_waitcnt vmcnt(11)
  v_add_f32 v204, v124, v144
  v_add_f32 v205, v125, v145
  v_add_f32 v206, v126, v146
  v_add_f32 v207, v127, v147
  s_waitcnt vmcnt(10)
  v_add_f32 v208, v128, v148
  v_add_f32 v209, v129, v149
  v_add_f32 v210, v130, v150
  v_add_f32 v211, v131, v151
  s_waitcnt vmcnt(9)
  v_add_f32 v192, v192, v152
  v_add_f32 v193, v193, v153
  v_add_f32 v194, v194, v154
  v_add_f32 v195, v195, v155
  s_waitcnt vmcnt(8)
  v_add_f32 v196, v196, v156
  v_add_f32 v197, v197, v157
  v_add_f32 v198, v198, v158
  v_add_f32 v199, v199, v159
  s_waitcnt vmcnt(7)
  v_add_f32 v200, v200, v160
  v_add_f32 v201, v201, v161
  v_add_f32 v202, v202, v162
  v_add_f32 v203, v203, v163
  s_waitcnt vmcnt(6)
  v_add_f32 v204, v204, v164
  v_add_f32 v205, v205, v165
  v_add_f32 v206, v206, v166
  v_add_f32 v207, v207, v167
  s_waitcnt vmcnt(5)
  v_add_f32 v208, v208, v168
  v_add_f32 v209, v209, v169
  v_add_f32 v210, v210, v170
  v_add_f32 v211, v211, v171
  s_waitcnt vmcnt(4)
  v_add_f32 v192, v192, v172
  v_add_f32 v193, v193, v173
  v_add_f32 v194, v194, v174
  v_add_f32 v195, v195, v175
  ds_write_b128 v15, v[192:195] offset:41312
  s_waitcnt vmcnt(3)
  v_add_f32 v196, v196, v176
  v_add_f32 v197, v197, v177
  v_add_f32 v198, v198, v178
  v_add_f32 v199, v199, v179
  ds_write_b128 v15, v[196:199] offset:42336
  s_waitcnt vmcnt(2)
  v_add_f32 v200, v200, v180
  v_add_f32 v201, v201, v181
  v_add_f32 v202, v202, v182
  v_add_f32 v203, v203, v183
  ds_write_b128 v15, v[200:203] offset:43360
  s_waitcnt vmcnt(1)
  v_add_f32 v204, v204, v184
  v_add_f32 v205, v205, v185
  v_add_f32 v206, v206, v186
  v_add_f32 v207, v207, v187
  ds_write_b128 v15, v[204:207] offset:44384
  s_waitcnt vmcnt(0)
  v_add_f32 v208, v208, v188
  v_add_f32 v209, v209, v189
  v_add_f32 v210, v210, v190
  v_add_f32 v211, v211, v191
  ds_write_b128 v15, v[208:211] offset:45408
  ds_read_b128 v[64:67], v15 offset:41312
  ds_read_b128 v[68:71], v15 offset:41952
  ds_read_b128 v[72:75], v15 offset:42592
  ds_read_b128 v[76:79], v15 offset:43232
  ds_read_b128 v[80:83], v15 offset:43872
  ds_read_b128 v[84:87], v15 offset:44512
  ds_read_b128 v[88:91], v15 offset:45152
  ds_read_b128 v[92:95], v15 offset:45792
  v_add_f32 v192, v192, v202
  v_add_f32 v193, v193, v203
  v_add_f32 v194, v194, v204
  v_add_f32 v195, v195, v205
  v_add_f32 v196, v196, v206
  v_add_f32 v197, v197, v207
  v_add_f32 v198, v198, v208
  v_add_f32 v199, v199, v209
  v_add_f32 v200, v200, v210
  v_add_f32 v201, v201, v211
  v_add_f32 v192, v192, v197
  v_add_f32 v193, v193, v198
  v_add_f32 v194, v194, v199
  v_add_f32 v195, v195, v200
  v_add_f32 v196, v196, v201
  v_add_f32 v192, v192, v193
  v_add_f32 v194, v194, v195
  v_add_f32 v192, v192, v196
  v_cmp_u_f32 vcc, v192, v194
  v_lshrrev_b32 v6, 1, v62
  s_waitcnt lgkmcnt(0)
  s_cbranch_vccnz L_chk
L_ok:
  v_add_f32 v64, v64, v80
  v_add_f32 v65, v65, v81
  v_add_f32 v66, v66, v82
  v_add_f32 v67, v67, v83
  v_add_f32 v68, v68, v84
  v_add_f32 v69, v69, v85
  v_add_f32 v70, v70, v86
  v_add_f32 v71, v71, v87
  v_add_f32 v72, v72, v88
  v_add_f32 v73, v73, v89
  v_add_f32 v74, v74, v90
  v_add_f32 v75, v75, v91
  v_add_f32 v76, v76, v92
  v_add_f32 v77, v77, v93
  v_add_f32 v78, v78, v94
  v_add_f32 v79, v79, v95
  v_add_f32 v64, v64, v72
  v_add_f32 v65, v65, v73
  v_add_f32 v66, v66, v74
  v_add_f32 v67, v67, v75
  v_add_f32 v68, v68, v76
  v_add_f32 v69, v69, v77
  v_add_f32 v70, v70, v78
  v_add_f32 v71, v71, v79
  v_add_f32 v64, v64, v68
  v_add_f32 v65, v65, v69
  v_add_f32 v66, v66, v70
  v_add_f32 v67, v67, v71
  v_cvt_pk_bf16_f32 v64, v64, v65
  v_cvt_pk_bf16_f32 v65, v66, v67
  s_mov_b32 exec_hi, 0xff
  buffer_store_dwordx2 v[64:65], v6, s[32:35], 0 offen
  s_mov_b32 exec_hi, -1
L_fin:
L_end:
  s_endpgm
L_dutyk:
  v_mov_b32 v63, 1
  s_mul_i32 s69, s78, 256
  s_add_u32 s70, s78, 17
  s_mul_i32 s70, s70, s100
  s_add_u32 s70, s70, s101
  s_and_b32 s70, s70, 31
  s_mul_i32 s70, s70, 16640
  s_add_u32 s69, s69, s70
  s_mov_b64 exec, 1
  buffer_atomic_add v63, v5, s[96:99], s69 offen sc0 sc1
  s_mov_b64 exec, -1
  s_branch L_selk
L_prock:
  v_readfirstlane_b32 s69, v63
  v_readfirstlane_b32 s79, v59
  s_min_u32 s69, s69, 7
  s_lshl_b32 s69, s69, 1
  s_sub_i32 s69, s69, 7
  s_mul_i32 s70, s69, 2
  s_add_i32 s79, s79, s70
  s_max_i32 s79, s79, 32
  s_min_i32 s79, s79, 256
  s_mul_i32 s69, s69, 16
  s_add_i32 s73, s69, s79
  v_mov_b32 v60, s73
  v_mov_b32 v61, s79
  ds_write_b64 v5, v[60:61] offset:13896
  s_branch L_selk
L_dutyv:
  v_mov_b32 v63, 1
  s_mul_i32 s69, s78, 256
  s_add_u32 s70, s78, 17
  s_mul_i32 s70, s70, s100
  s_add_u32 s70, s70, s101
  s_and_b32 s70, s70, 31
  s_mul_i32 s70, s70, 16640
  s_add_u32 s69, s69, s70
  s_mov_b64 exec, 1
  buffer_atomic_add v63, v5, s[96:99], s69 offen sc0 sc1
  s_mov_b64 exec, -1
  s_branch L_selv
L_procv:
  v_readfirstlane_b32 s69, v63
  v_readfirstlane_b32 s79, v59
  s_min_u32 s69, s69, 7
  s_lshl_b32 s69, s69, 1
  s_sub_i32 s69, s69, 7
  s_mul_i32 s70, s69, 2
  s_add_i32 s79, s79, s70
  s_max_i32 s79, s79, 32
  s_min_i32 s79, s79, 256
  s_mul_i32 s69, s69, 16
  s_add_i32 s73, s69, s79
  v_mov_b32 v60, s73
  v_mov_b32 v61, s79
  ds_write_b64 v5, v[60:61] offset:13896
  s_branch L_selv
L_chk:
  v_max3_u32 v192, v112, v113, v114
  v_max3_u32 v193, v132, v133, v134
  v_max3_u32 v194, v152, v153, v154
  v_max3_u32 v195, v172, v173, v174
  v_max3_u32 v192, v115, v116, v192
  v_max3_u32 v193, v135, v136, v193
  v_max3_u32 v194, v155, v156, v194
  v_max3_u32 v195, v175, v176, v195
  v_max3_u32 v192, v117, v118, v192
  v_max3_u32 v193, v137, v138, v193
  v_max3_u32 v194, v157, v158, v194
  v_max3_u32 v195, v177, v178, v195
  v_max3_u32 v192, v119, v120, v192
  v_max3_u32 v193, v139, v140, v193
  v_max3_u32 v194, v159, v160, v194
  v_max3_u32 v195, v179, v180, v195
  v_max3_u32 v192, v121, v122, v192
  v_max3_u32 v193, v141, v142, v193
  v_max3_u32 v194, v161, v162, v194
  v_max3_u32 v195, v181, v182, v195
  v_max3_u32 v192, v123, v124, v192
  v_max3_u32 v193, v143, v144, v193
  v_max3_u32 v194, v163, v164, v194
  v_max3_u32 v195, v183, v184, v195
  v_max3_u32 v192, v125, v126, v192
  v_max3_u32 v193, v145, v146, v193
  v_max3_u32 v194, v165, v166, v194
  v_max3_u32 v195, v185, v186, v195
  v_max3_u32 v192, v127, v128, v192
  v_max3_u32 v193, v147, v148, v193
  v_max3_u32 v194, v167, v168, v194
  v_max3_u32 v195, v187, v188, v195
  v_max3_u32 v192, v129, v130, v192
  v_max3_u32 v193, v149, v150, v193
  v_max3_u32 v194, v169, v170, v194
  v_max3_u32 v195, v189, v190, v195
  v_max3_u32 v192, v131, v171, v192
  v_max3_u32 v193, v151, v191, v193
  v_max3_u32 v192, v192, v193, v194
  v_max_u32 v192, v192, v195
  v_cmp_eq_u32 vcc, -1, v192
  s_nop 4
  s_cbranch_vccz L_ok
  s_sub_u32 s78, s78, 1
  s_cmp_lg_u32 s78, 0
  s_cbranch_scc1 L_poll
  s_branch L_ok
.section .rodata,"a"
.p2align 6
.amdhsa_kernel standalone__gqa_block_cached__decode_kernel
  .amdhsa_next_free_vgpr 512
  .amdhsa_next_free_sgpr 102
  .amdhsa_accum_offset 256
  .amdhsa_group_segment_fixed_size 0
  .amdhsa_kernarg_size 64
  .amdhsa_user_sgpr_count 2
  .amdhsa_user_sgpr_kernarg_segment_ptr 1
  .amdhsa_system_sgpr_workgroup_id_x 1
.end_amdhsa_kernel
```
